```python
import torch

def _softmax(x, axis=-1):
    return torch.softmax(x, dim=axis)
def _gelu(x):
    return torch.nn.functional.gelu(x, approximate="tanh")
def _silu(x):
    return torch.nn.functional.silu(x)
def _sigmoid(x):
    return torch.sigmoid(x)
def _layernorm(x, axis=-1, eps=1e-5):
    m = x.mean(dim=axis, keepdim=True)
    v = x.var(dim=axis, keepdim=True, unbiased=False)
    return (x - m) / torch.sqrt(v + eps)
def _scatter_add(tgt, idx, src, axis=0):
    return tgt.clone().index_add_(axis, idx, src)
def _segment_sum(src, seg, n):
    out = torch.zeros((n,) + src.shape[1:], dtype=src.dtype)
    return out.index_add_(0, seg, src)
def _pad(x, pw):
    flat = tuple(v for pair in reversed(pw) for v in pair)
    return torch.nn.functional.pad(x, flat)

kernel_name = 'recurrent_scan__linear_kernel_hedgehog__geglu_ffn__prompt'

def setup_inputs():

    _w = (lambda a: (lambda t: t.to(torch.bfloat16) if t.is_floating_point() else t)(torch.as_tensor(a)))
    def _A_setup():
        B, S, D, H = 1, 2048, 448, 16
        Dh = D // H
        return {
            "x": _w((lambda *s: torch.randn(*s, dtype=torch.bfloat16) * 0.05)(B, S, D)),
            "wqkv": _w((lambda *s: torch.randn(*s, dtype=torch.bfloat16) * 0.4)(D, 3 * D)),
            "w_phi": _w((lambda *s: torch.randn(*s, dtype=torch.bfloat16) * 0.4)(H, Dh, Dh) * (Dh ** -0.5)),
            "wo": _w((lambda *s: torch.randn(*s, dtype=torch.bfloat16) * 0.05)(D, D)),
        }
    _A_in = _A_setup()

    def _B_setup():
        B, S, D, F = 1, 2048, 448, 1792
        return {
            "x": _w((lambda *s: torch.randn(*s, dtype=torch.bfloat16) * 0.05)(B, S, D)),
            "w_gate": _w((lambda *s: torch.randn(*s, dtype=torch.bfloat16) * 0.05)(D, F)),
            "w_up": _w((lambda *s: torch.randn(*s, dtype=torch.bfloat16) * 0.05)(D, F)),
            "w_down": _w((lambda *s: torch.randn(*s, dtype=torch.bfloat16) * 0.05)(F, D)),
        }
    _B_in = _B_setup()

    return {
        "A_x": _A_in["x"],
        "A_wqkv": _A_in["wqkv"],
        "A_w_phi": _A_in["w_phi"],
        "A_wo": _A_in["wo"],
        "B_x": _B_in["x"],
        "B_w_gate": _B_in["w_gate"],
        "B_w_up": _B_in["w_up"],
        "B_w_down": _B_in["w_down"],
    }

def reference(A_x, A_wqkv, A_w_phi, A_wo, B_x, B_w_gate, B_w_up, B_w_down):
    def _A_ref(x, wqkv, w_phi, wo):
        B, S, D = x.shape
        H = 16; Dh = D // H
        qkv = (lambda x, *d: x.permute(*d))((x @ wqkv).reshape(B, S, 3, H, Dh), 2, 0, 3, 1, 4)
        q, k, v = qkv[0], qkv[1], qkv[2]
        pq = torch.einsum("bhsd,hdf->bhsf", q, w_phi)
        pk = torch.einsum("bhsd,hdf->bhsf", k, w_phi)
        phi_q = torch.concatenate([_softmax(pq, axis=-1), _softmax(-pq, axis=-1)], axis=-1)
        phi_k = torch.concatenate([_softmax(pk, axis=-1), _softmax(-pk, axis=-1)], axis=-1)
        kv = torch.einsum("bhsf,bhsd->bhfd", phi_k, v)
        z  = torch.einsum("bhsf->bhf", phi_k)
        num = torch.einsum("bhqf,bhfd->bhqd", phi_q, kv)
        den = torch.einsum("bhqf,bhf->bhq", phi_q, z)[..., None] + 1e-6
        o = num / den
        return (lambda x, *d: x.permute(*d))(o, 0, 2, 1, 3).reshape(B, S, D) @ wo

    def _B_ref(x, w_gate, w_up, w_down):
        return (_gelu(x @ w_gate) * (x @ w_up)) @ w_down

    x = A_x
    xn = _layernorm(x, axis=-1)
    s = _A_ref(xn, A_wqkv, A_w_phi, A_wo)
    g = _silu(_B_ref(xn, B_w_gate, B_w_up, B_w_down))
    return x + s * g
```

```asm
; @launch grid=(256,1,1) block=(512,1,1) lds=163840
.amdgcn_target "amdgcn-amd-amdhsa--gfx950"
.text
.globl recurrent_scan__linear_kernel_hedgehog__geglu_ffn__prompt_kernel
.p2align 8
.type recurrent_scan__linear_kernel_hedgehog__geglu_ffn__prompt_kernel,@function
recurrent_scan__linear_kernel_hedgehog__geglu_ffn__prompt_kernel:
    s_cmp_ge_u32 s2, 256
    s_cbranch_scc1 L_end
    s_load_dwordx4 s[8:11], s[0:1], 0
    s_getpc_b64 s[80:81]
L_pcbase:
    s_lshr_b32 s61, s2, 3
    v_lshrrev_b32 v48, 6, v0
    v_and_b32 v49, 1, v0
    v_lshl_or_b32 v49, v48, 1, v49
    s_lshl_b32 s64, s61, 4
    v_add_u32 v49, s64, v49
    v_lshlrev_b32 v49, 7, v49
    v_min_u32 v49, (L_codeend - L_pcbase - 4), v49
    global_load_dword v56, v49, s[80:81]
    v_readfirstlane_b32 s48, v48
    s_and_b32 s60, s2, 7
    v_and_b32 v1, 63, v0
    s_and_b32 s64, s60, 1
    s_lshl_b32 s64, s64, 3
    s_and_b32 s65, s61, 7
    s_add_u32 s49, s64, s65
    s_lshr_b32 s66, s61, 3
    s_lshr_b32 s64, s60, 1
    s_lshl_b32 s64, s64, 2
    s_add_u32 s50, s64, s66
    v_lshrrev_b32 v50, 3, v1
    s_lshl_b32 s66, s66, 1
    s_add_u32 s65, s65, s66
    v_lshrrev_b32 v51, 4, v1
    s_sub_u32 s66, s65, 7
    s_cmp_ge_u32 s65, 7
    s_cselect_b32 s65, s66, s65
    v_and_b32 v52, 7, v1
    s_lshl_b32 s65, s65, 2
    s_mov_b32 s66, 0x06543210
    s_mov_b32 s67, 0x00654321
    s_lshr_b64 s[66:67], s[66:67], s65
    s_mov_b32 s53, s66
    s_lshl_b32 s54, s48, 10
    s_lshl_b32 s64, s49, 7
    s_lshl_b32 s65, s48, 3
    s_add_u32 s64, s64, s65
    v_add_u32 v31, s64, v50
    v_mul_u32_u24 v31, 896, v31
    s_and_b32 s65, s48, 1
    s_lshl_b32 s65, s65, 2
    v_xor_b32 v51, s65, v51
    v_xor_b32 v51, v51, v52
    v_lshl_add_u32 v31, v51, 4, v31
    s_mov_b32 s14, 1204224
    s_mov_b32 s15, 0x20000
    s_waitcnt lgkmcnt(0)
    s_mov_b32 s12, s10
    s_mov_b32 s13, s11
    s_mov_b32 s10, 1835008
    s_mov_b32 s11, 0x20000
    s_add_u32 m0, s54, 0
    s_bfe_u32 s64, s53, 0x00040000
    s_lshl_b32 s64, s64, 7
    buffer_load_dwordx4 v31, s[8:11], s64 offen lds
    s_add_u32 m0, s54, 8192
    s_add_u32 s64, s64, 57344
    buffer_load_dwordx4 v31, s[8:11], s64 offen lds
    s_load_dwordx2 s[16:17], s[0:1], 40
    s_load_dwordx2 s[20:21], s[0:1], 48
    s_load_dwordx2 s[40:41], s[0:1], 16
    s_load_dwordx2 s[28:29], s[0:1], 24
    s_load_dwordx2 s[24:25], s[0:1], 56
    s_load_dwordx2 s[36:37], s[0:1], 64
    s_load_dwordx2 s[32:33], s[0:1], 80
    s_and_b32 s58, s48, 3
    s_cmp_ge_u32 s48, 4
    s_cbranch_scc1 L_half1
L_half0:
    s_lshl_b32 s65, s58, 4
    v_lshrrev_b32 v53, 2, v1
    v_add_u32 v53, s65, v53
    v_mul_u32_u24 v8, 2688, v53
    v_and_b32 v53, 3, v1
    v_lshlrev_b32 v53, 4, v53
    v_min_u32 v53, 40, v53
    s_mul_i32 s65, s50, 56
    v_add3_u32 v8, v8, v53, s65
    s_add_u32 m0, s54, 114688
    s_bfe_u32 s64, s53, 0x00040000
    s_mul_i32 s64, s64, 172032
    s_add_u32 s64, s64, 896
    buffer_load_dwordx4 v8, s[12:15], s64 offen lds
    v_and_b32 v53, 31, v1
    v_lshrrev_b32 v54, 5, v1
    v_bfe_u32 v49, v1, 1, 3
    v_xor_b32 v49, v49, v54
    v_lshlrev_b32 v53, 7, v53
    s_add_u32 m0, s54, 16384
    s_bfe_u32 s64, s53, 0x00040004
    s_lshl_b32 s64, s64, 7
    buffer_load_dwordx4 v31, s[8:11], s64 offen lds
    s_lshl_b32 s65, s58, 12
    v_add_u32 v53, s65, v53
    s_mov_b32 s70, 0x3f803f80
    v_xor_b32 v24, 0, v49
    v_lshl_add_u32 v24, v24, 4, v53
    v_xor_b32 v25, 2, v49
    s_add_u32 m0, s54, 24576
    s_add_u32 s64, s64, 57344
    buffer_load_dwordx4 v31, s[8:11], s64 offen lds
    v_lshl_add_u32 v25, v25, 4, v53
    v_xor_b32 v26, 4, v49
    v_lshl_add_u32 v26, v26, 4, v53
    v_xor_b32 v27, 6, v49
    s_add_u32 m0, s54, 122880
    s_bfe_u32 s64, s53, 0x00040004
    s_mul_i32 s64, s64, 172032
    s_add_u32 s64, s64, 896
    buffer_load_dwordx4 v8, s[12:15], s64 offen lds
    v_lshl_add_u32 v27, v27, 4, v53
    v_bfe_u32 v39, v1, 4, 1
    v_bfe_u32 v36, v1, 2, 2
    v_lshrrev_b32 v37, 5, v1
    s_add_u32 m0, s54, 32768
    s_bfe_u32 s64, s53, 0x00040008
    s_lshl_b32 s64, s64, 7
    buffer_load_dwordx4 v31, s[8:11], s64 offen lds
    v_and_b32 v38, 3, v1
    v_lshl_add_u32 v37, v37, 3, v36
    v_lshlrev_b32 v11, 6, v37
    v_lshl_add_u32 v11, v39, 5, v11
    v_lshl_add_u32 v11, v38, 3, v11
    s_add_u32 m0, s54, 40960
    s_add_u32 s64, s64, 57344
    buffer_load_dwordx4 v31, s[8:11], s64 offen lds
    v_add_u32 v11, 114688, v11
    s_lshl_b32 s65, s58, 10
    v_add_u32 v14, s65, v11
    v_lshrrev_b32 v35, 2, v1
    v_xor_b32 v35, v35, v39
    s_add_u32 m0, s54, 131072
    s_bfe_u32 s64, s53, 0x00040008
    s_mul_i32 s64, s64, 172032
    s_add_u32 s64, s64, 896
    buffer_load_dwordx4 v8, s[12:15], s64 offen lds
    v_and_b32 v35, 1, v35
    v_cmp_eq_u32 vcc, 0, v35
    v_mov_b32 v35, s70
    s_nop 0
    v_cndmask_b32 v240, 0, v35, vcc
    v_mov_b32 v241, v240
    v_mov_b32 v242, v240
    v_mov_b32 v243, v240
    s_mov_b32 s18, 1605632
    s_mov_b32 s19, 0x20000
    s_mov_b32 s22, 1605632
    s_mov_b32 s23, 0x20000
    s_mov_b32 s42, 25088
    s_mov_b32 s43, 0x20000
    s_mov_b32 s30, 401408
    s_mov_b32 s31, 0x20000
    s_mov_b32 s26, 1605632
    s_mov_b32 s27, 0x20000
    s_mov_b32 s38, 1835008
    s_mov_b32 s39, 0x20000
    s_mov_b32 s34, 11796480
    s_mov_b32 s35, 0x20000
    s_lshl_b32 s90, s58, 10
    s_waitcnt lgkmcnt(0)
    s_mov_b32 s66, 0x67542310
    s_mov_b32 s67, 0xfecdba89
    s_lshl_b32 s65, s50, 2
    s_lshr_b64 s[66:67], s[66:67], s65
    s_and_b32 s51, s66, 15
    s_and_b32 s52, s51, 3
    s_mov_b32 s44, s16
    s_mov_b32 s45, s17
    s_lshl_b32 s55, s58, 10
    s_lshl_b32 s66, s58, 6
    s_mov_b32 s65, 0
    s_mov_b32 s46, 1605632
    s_mov_b32 s47, 0x20000
    s_mul_i32 s67, s51, 224
    v_add_u32 v53, s66, v1
    v_mul_u32_u24 v54, 683, v53
    v_lshrrev_b32 v54, 12, v54
    v_mul_u32_u24 v55, 6, v54
    v_sub_u32 v55, v53, v55
    v_xor_b32 v54, s65, v54
    v_mul_u32_u24 v9, 3584, v54
    v_lshrrev_b32 v54, 1, v55
    v_add_u32 v53, 4, v54
    v_cmp_gt_u32 vcc, s52, v54
    v_and_b32 v55, 1, v55
    s_nop 0
    v_cndmask_b32 v54, v53, v54, vcc
    v_lshl_or_b32 v54, v54, 1, v55
    v_lshlrev_b32 v54, 4, v54
    v_add3_u32 v9, v9, v54, s67
    s_lshl_b32 s65, s58, 3
    v_add_u32 v53, s65, v50
    v_bfe_u32 v51, v1, 4, 1
    v_lshlrev_b32 v49, 1, v51
    v_xor_b32 v49, v49, v52
    s_lshl_b32 s66, s52, 5
    s_add_u32 s66, s66, s67
    v_mul_u32_u24 v19, 3584, v53
    v_add_u32 v19, s66, v19
    v_lshl_add_u32 v17, v49, 4, v19
    v_xor_b32 v49, 4, v49
    v_lshl_add_u32 v18, v49, 4, v19
    s_mul_i32 s66, s61, 37
    s_lshr_b32 s66, s66, 8
    s_mul_i32 s67, s66, 7
    s_sub_u32 s75, s61, s67
    s_lshl_b32 s67, s60, 2
    s_add_u32 s66, s66, s67
    s_lshl_b32 s66, s66, 1
    s_add_u32 s76, s66, 0
    s_and_b32 s76, s76, 63
    v_lshlrev_b32 v49, 2, v51
    v_xor_b32 v49, v49, v52
    v_mul_u32_u24 v53, 896, v53
    s_lshl_b32 s66, s75, 7
    v_add_u32 v53, s66, v53
    v_lshl_add_u32 v19, v49, 4, v53
    v_lshlrev_b32 v2, 4, v1
    v_cmp_lt_u32 vcc, 31, v1
    v_mov_b32 v248, 0
    v_mov_b32 v249, 0
    v_cndmask_b32 v3, 0, 1.0, vcc
    s_mov_b32 s62, 0x3fb8aa3b
    s_mov_b32 s71, 0x00003f80
    s_mov_b32 s72, 0x3f800000
    s_lshl_b32 s59, s49, 2
    s_add_u32 s59, s59, s58
    s_mul_i32 s63, s59, 151552
    s_add_u32 s63, s63, 2097152
    s_lshl_b32 s78, s59, 10
    s_lshl_b32 s66, s51, 3
    s_add_u32 s78, s78, s66
    s_add_u32 s78, s78, 65536
    s_mul_i32 s73, s76, 151552
    s_lshl_b32 s66, s58, 10
    s_add_u32 s73, s73, s66
    s_add_u32 s73, s73, 2097152
    s_lshl_b32 s74, s76, 10
    s_add_u32 s74, s74, 65536
    s_lshr_b32 s77, s58, 1
    s_add_u32 s77, s77, 2
    s_lshl_b32 s77, s77, 7
    s_add_u32 s77, s77, s74
    s_lshl_b32 s82, s50, 2
    s_add_u32 s82, s82, s58
    s_lshl_b32 s82, s82, 7
    s_add_u32 s82, s82, 4096
    s_mov_b32 s66, 20480
    v_xor_b32 v49, 0, v39
    v_lshl_add_u32 v49, v49, 2, v37
    v_mul_u32_u24 v49, 96, v49
    v_mul_u32_u24 v12, 6144, v39
    v_lshl_add_u32 v49, v38, 3, v49
    v_add3_u32 v12, v12, v49, s66
    v_xor_b32 v49, 1, v39
    v_lshl_add_u32 v49, v49, 2, v37
    v_mul_u32_u24 v49, 96, v49
    v_mul_u32_u24 v13, 6144, v39
    v_lshl_add_u32 v49, v38, 3, v49
    v_add3_u32 v13, v13, v49, s66
    v_lshrrev_b32 v49, 1, v36
    v_lshl_or_b32 v49, v39, 1, v49
    v_lshlrev_b32 v37, 7, v37
    v_lshl_add_u32 v37, v39, 13, v37
    v_lshl_add_u32 v37, v38, 3, v37
    v_xor_b32 v20, 0, v49
    v_lshl_add_u32 v20, v20, 5, v37
    v_xor_b32 v21, 1, v49
    v_lshl_add_u32 v21, v21, 5, v37
    s_mul_i32 s65, s58, 1536
    v_add_u32 v15, s65, v12
    v_add_u32 v16, s65, v13
    v_mov_b32 v28, 0
    v_mov_b32 v29, 0
    s_waitcnt vmcnt(6)
    s_barrier
    ds_read_b128 v[128:131], v24 offset:0
    ds_read_b64_tr_b16 v[80:81], v11 offset:0
    ds_read_b64_tr_b16 v[82:83], v11 offset:256
    ds_read_b128 v[132:135], v25 offset:0
    ds_read_b64_tr_b16 v[84:85], v11 offset:1024
    ds_read_b64_tr_b16 v[86:87], v11 offset:1280
    ds_read_b128 v[136:139], v26 offset:0
    ds_read_b64_tr_b16 v[88:89], v11 offset:2048
    ds_read_b64_tr_b16 v[90:91], v11 offset:2304
    ds_read_b128 v[140:143], v27 offset:0
    ds_read_b64_tr_b16 v[92:93], v11 offset:3072
    ds_read_b64_tr_b16 v[94:95], v11 offset:3328
    ds_read_b64_tr_b16 v[250:251], v14 offset:0
    ds_read_b64_tr_b16 v[252:253], v14 offset:256
    s_waitcnt lgkmcnt(0)
    s_waitcnt vmcnt(3)
    s_barrier
    v_mfma_f32_32x32x16_bf16 v[64:79], v[80:83], v[128:131], 0
    s_add_u32 m0, s54, 49152
    s_bfe_u32 s64, s53, 0x0004000c
    s_lshl_b32 s64, s64, 7
    buffer_load_dwordx4 v31, s[8:11], s64 offen lds
    v_mfma_f32_16x16x32_bf16 v[56:59], v[240:243], v[250:253], 0
    ds_read_b128 v[144:147], v24 offset:16384
    ds_read_b64_tr_b16 v[96:97], v11 offset:8192
    ds_read_b64_tr_b16 v[98:99], v11 offset:8448
    ds_read_b128 v[148:151], v25 offset:16384
    v_mfma_f32_32x32x16_bf16 v[64:79], v[84:87], v[132:135], v[64:79]
    ds_read_b64_tr_b16 v[100:101], v11 offset:9216
    ds_read_b64_tr_b16 v[102:103], v11 offset:9472
    ds_read_b128 v[152:155], v26 offset:16384
    v_mfma_f32_32x32x16_bf16 v[64:79], v[88:91], v[136:139], v[64:79]
    s_add_u32 m0, s54, 57344
    s_add_u32 s64, s64, 57344
    buffer_load_dwordx4 v31, s[8:11], s64 offen lds
    ds_read_b64_tr_b16 v[104:105], v11 offset:10240
    ds_read_b64_tr_b16 v[106:107], v11 offset:10496
    ds_read_b128 v[156:159], v27 offset:16384
    ds_read_b64_tr_b16 v[108:109], v11 offset:11264
    v_mfma_f32_32x32x16_bf16 v[64:79], v[92:95], v[140:143], v[64:79]
    ds_read_b64_tr_b16 v[110:111], v11 offset:11520
    ds_read_b64_tr_b16 v[250:251], v14 offset:8192
    ds_read_b64_tr_b16 v[252:253], v14 offset:8448
    v_dot2c_f32_bf16 v28, s70, v128
    v_dot2c_f32_bf16 v29, v128, v128
    s_add_u32 m0, s54, 139264
    s_bfe_u32 s64, s53, 0x0004000c
    s_mul_i32 s64, s64, 172032
    s_add_u32 s64, s64, 896
    buffer_load_dwordx4 v8, s[12:15], s64 offen lds
    v_dot2c_f32_bf16 v28, s70, v129
    v_dot2c_f32_bf16 v29, v129, v129
    v_dot2c_f32_bf16 v28, s70, v130
    v_dot2c_f32_bf16 v29, v130, v130
    v_dot2c_f32_bf16 v28, s70, v131
    v_dot2c_f32_bf16 v29, v131, v131
    v_dot2c_f32_bf16 v28, s70, v132
    v_dot2c_f32_bf16 v29, v132, v132
    v_dot2c_f32_bf16 v28, s70, v133
    v_dot2c_f32_bf16 v29, v133, v133
    v_dot2c_f32_bf16 v28, s70, v134
    v_dot2c_f32_bf16 v29, v134, v134
    v_dot2c_f32_bf16 v28, s70, v135
    v_dot2c_f32_bf16 v29, v135, v135
    s_waitcnt lgkmcnt(0)
    s_waitcnt vmcnt(3)
    s_barrier
    v_mfma_f32_32x32x16_bf16 v[64:79], v[96:99], v[144:147], v[64:79]
    s_add_u32 m0, s54, 65536
    s_bfe_u32 s64, s53, 0x00040010
    s_lshl_b32 s64, s64, 7
    buffer_load_dwordx4 v31, s[8:11], s64 offen lds
    v_mfma_f32_16x16x32_bf16 v[56:59], v[240:243], v[250:253], v[56:59]
    ds_read_b128 v[160:163], v24 offset:32768
    ds_read_b64_tr_b16 v[80:81], v11 offset:16384
    ds_read_b64_tr_b16 v[82:83], v11 offset:16640
    ds_read_b128 v[164:167], v25 offset:32768
    v_mfma_f32_32x32x16_bf16 v[64:79], v[100:103], v[148:151], v[64:79]
    ds_read_b64_tr_b16 v[84:85], v11 offset:17408
    ds_read_b64_tr_b16 v[86:87], v11 offset:17664
    ds_read_b128 v[168:171], v26 offset:32768
    v_mfma_f32_32x32x16_bf16 v[64:79], v[104:107], v[152:155], v[64:79]
    s_add_u32 m0, s54, 73728
    s_add_u32 s64, s64, 57344
    buffer_load_dwordx4 v31, s[8:11], s64 offen lds
    ds_read_b64_tr_b16 v[88:89], v11 offset:18432
    ds_read_b64_tr_b16 v[90:91], v11 offset:18688
    ds_read_b128 v[172:175], v27 offset:32768
    ds_read_b64_tr_b16 v[92:93], v11 offset:19456
    v_mfma_f32_32x32x16_bf16 v[64:79], v[108:111], v[156:159], v[64:79]
    ds_read_b64_tr_b16 v[94:95], v11 offset:19712
    ds_read_b64_tr_b16 v[250:251], v14 offset:16384
    ds_read_b64_tr_b16 v[252:253], v14 offset:16640
    v_dot2c_f32_bf16 v28, s70, v144
    v_dot2c_f32_bf16 v29, v144, v144
    s_add_u32 m0, s54, 147456
    s_bfe_u32 s64, s53, 0x00040010
    s_mul_i32 s64, s64, 172032
    s_add_u32 s64, s64, 896
    buffer_load_dwordx4 v8, s[12:15], s64 offen lds
    v_dot2c_f32_bf16 v28, s70, v145
    v_dot2c_f32_bf16 v29, v145, v145
    v_dot2c_f32_bf16 v28, s70, v146
    v_dot2c_f32_bf16 v29, v146, v146
    v_dot2c_f32_bf16 v28, s70, v147
    v_dot2c_f32_bf16 v29, v147, v147
    v_dot2c_f32_bf16 v28, s70, v148
    v_dot2c_f32_bf16 v29, v148, v148
    v_dot2c_f32_bf16 v28, s70, v149
    v_dot2c_f32_bf16 v29, v149, v149
    v_dot2c_f32_bf16 v28, s70, v150
    v_dot2c_f32_bf16 v29, v150, v150
    v_dot2c_f32_bf16 v28, s70, v151
    v_dot2c_f32_bf16 v29, v151, v151
    s_waitcnt lgkmcnt(0)
    s_waitcnt vmcnt(3)
    s_barrier
    v_mfma_f32_32x32x16_bf16 v[64:79], v[80:83], v[160:163], v[64:79]
    s_add_u32 m0, s54, 81920
    s_bfe_u32 s64, s53, 0x00040014
    s_lshl_b32 s64, s64, 7
    buffer_load_dwordx4 v31, s[8:11], s64 offen lds
    v_mfma_f32_16x16x32_bf16 v[56:59], v[240:243], v[250:253], v[56:59]
    ds_read_b128 v[176:179], v24 offset:49152
    ds_read_b64_tr_b16 v[96:97], v11 offset:24576
    ds_read_b64_tr_b16 v[98:99], v11 offset:24832
    ds_read_b128 v[180:183], v25 offset:49152
    v_mfma_f32_32x32x16_bf16 v[64:79], v[84:87], v[164:167], v[64:79]
    ds_read_b64_tr_b16 v[100:101], v11 offset:25600
    ds_read_b64_tr_b16 v[102:103], v11 offset:25856
    ds_read_b128 v[184:187], v26 offset:49152
    v_mfma_f32_32x32x16_bf16 v[64:79], v[88:91], v[168:171], v[64:79]
    s_add_u32 m0, s54, 90112
    s_add_u32 s64, s64, 57344
    buffer_load_dwordx4 v31, s[8:11], s64 offen lds
    ds_read_b64_tr_b16 v[104:105], v11 offset:26624
    ds_read_b64_tr_b16 v[106:107], v11 offset:26880
    ds_read_b128 v[188:191], v27 offset:49152
    ds_read_b64_tr_b16 v[108:109], v11 offset:27648
    v_mfma_f32_32x32x16_bf16 v[64:79], v[92:95], v[172:175], v[64:79]
    ds_read_b64_tr_b16 v[110:111], v11 offset:27904
    ds_read_b64_tr_b16 v[250:251], v14 offset:24576
    ds_read_b64_tr_b16 v[252:253], v14 offset:24832
    v_dot2c_f32_bf16 v28, s70, v160
    v_dot2c_f32_bf16 v29, v160, v160
    s_add_u32 m0, s54, 0
    s_bfe_u32 s64, s53, 0x00040014
    s_mul_i32 s64, s64, 172032
    s_add_u32 s64, s64, 896
    buffer_load_dwordx4 v8, s[12:15], s64 offen lds
    v_dot2c_f32_bf16 v28, s70, v161
    v_dot2c_f32_bf16 v29, v161, v161
    v_dot2c_f32_bf16 v28, s70, v162
    v_dot2c_f32_bf16 v29, v162, v162
    v_dot2c_f32_bf16 v28, s70, v163
    v_dot2c_f32_bf16 v29, v163, v163
    v_dot2c_f32_bf16 v28, s70, v164
    v_dot2c_f32_bf16 v29, v164, v164
    v_dot2c_f32_bf16 v28, s70, v165
    v_dot2c_f32_bf16 v29, v165, v165
    v_dot2c_f32_bf16 v28, s70, v166
    v_dot2c_f32_bf16 v29, v166, v166
    v_dot2c_f32_bf16 v28, s70, v167
    v_dot2c_f32_bf16 v29, v167, v167
    s_waitcnt lgkmcnt(0)
    s_waitcnt vmcnt(3)
    s_barrier
    v_mfma_f32_32x32x16_bf16 v[64:79], v[96:99], v[176:179], v[64:79]
    v_mfma_f32_16x16x32_bf16 v[56:59], v[240:243], v[250:253], v[56:59]
    s_add_u32 m0, s54, 98304
    s_bfe_u32 s64, s53, 0x00040018
    s_lshl_b32 s64, s64, 7
    buffer_load_dwordx4 v31, s[8:11], s64 offen lds
    v_add_u32 v24, 0x10000, v24
    v_add_u32 v25, 0x10000, v25
    v_add_u32 v26, 0x10000, v26
    v_add_u32 v27, 0x10000, v27
    ds_read_b128 v[192:195], v24 offset:0
    v_mfma_f32_32x32x16_bf16 v[64:79], v[100:103], v[180:183], v[64:79]
    ds_read_b64_tr_b16 v[80:81], v11 offset:32768
    ds_read_b64_tr_b16 v[82:83], v11 offset:33024
    ds_read_b128 v[196:199], v25 offset:0
    ds_read_b64_tr_b16 v[84:85], v11 offset:33792
    v_mfma_f32_32x32x16_bf16 v[64:79], v[104:107], v[184:187], v[64:79]
    s_add_u32 m0, s54, 106496
    s_add_u32 s64, s64, 57344
    buffer_load_dwordx4 v31, s[8:11], s64 offen lds
    ds_read_b64_tr_b16 v[86:87], v11 offset:34048
    ds_read_b128 v[200:203], v26 offset:0
    ds_read_b64_tr_b16 v[88:89], v11 offset:34816
    ds_read_b64_tr_b16 v[90:91], v11 offset:35072
    ds_read_b128 v[204:207], v27 offset:0
    v_mfma_f32_32x32x16_bf16 v[64:79], v[108:111], v[188:191], v[64:79]
    ds_read_b64_tr_b16 v[92:93], v11 offset:35840
    ds_read_b64_tr_b16 v[94:95], v11 offset:36096
    ds_read_b64_tr_b16 v[250:251], v14 offset:32768
    ds_read_b64_tr_b16 v[252:253], v14 offset:33024
    v_dot2c_f32_bf16 v28, s70, v176
    s_add_u32 m0, s54, 8192
    s_bfe_u32 s64, s53, 0x00040018
    s_mul_i32 s64, s64, 172032
    s_add_u32 s64, s64, 896
    buffer_load_dwordx4 v8, s[12:15], s64 offen lds
    v_dot2c_f32_bf16 v29, v176, v176
    v_dot2c_f32_bf16 v28, s70, v177
    v_dot2c_f32_bf16 v29, v177, v177
    v_dot2c_f32_bf16 v28, s70, v178
    v_dot2c_f32_bf16 v29, v178, v178
    v_dot2c_f32_bf16 v28, s70, v179
    v_dot2c_f32_bf16 v29, v179, v179
    v_dot2c_f32_bf16 v28, s70, v180
    v_dot2c_f32_bf16 v29, v180, v180
    v_dot2c_f32_bf16 v28, s70, v181
    v_dot2c_f32_bf16 v29, v181, v181
    v_dot2c_f32_bf16 v28, s70, v182
    v_dot2c_f32_bf16 v29, v182, v182
    v_dot2c_f32_bf16 v28, s70, v183
    v_dot2c_f32_bf16 v29, v183, v183
    s_waitcnt lgkmcnt(0)
    s_waitcnt vmcnt(3)
    s_barrier
    v_mfma_f32_32x32x16_bf16 v[64:79], v[80:83], v[192:195], v[64:79]
    v_mfma_f32_16x16x32_bf16 v[56:59], v[240:243], v[250:253], v[56:59]
    s_add_u32 m0, s90, 16384
    s_bfe_u32 s64, s53, 0x00040000
    s_mul_i32 s64, s64, 172032
    buffer_load_dwordx4 v8, s[12:15], s64 offen lds
    v_add_u32 v11, 0xfffe4000, v11
    ds_read_b128 v[208:211], v24 offset:16384
    ds_read_b64_tr_b16 v[96:97], v11 offset:0
    ds_read_b64_tr_b16 v[98:99], v11 offset:256
    v_mfma_f32_32x32x16_bf16 v[64:79], v[84:87], v[196:199], v[64:79]
    ds_read_b128 v[212:215], v25 offset:16384
    ds_read_b64_tr_b16 v[100:101], v11 offset:1024
    ds_read_b64_tr_b16 v[102:103], v11 offset:1280
    ds_read_b128 v[216:219], v26 offset:16384
    v_mfma_f32_32x32x16_bf16 v[64:79], v[88:91], v[200:203], v[64:79]
    s_add_u32 m0, s55, 20480
    s_bfe_u32 s64, s53, 0x00040000
    s_mul_i32 s64, s64, 229376
    buffer_load_dwordx4 v9, s[44:47], s64 offen lds
    ds_read_b64_tr_b16 v[104:105], v11 offset:2048
    ds_read_b64_tr_b16 v[106:107], v11 offset:2304
    ds_read_b128 v[220:223], v27 offset:16384
    ds_read_b64_tr_b16 v[108:109], v11 offset:3072
    v_mfma_f32_32x32x16_bf16 v[64:79], v[92:95], v[204:207], v[64:79]
    ds_read_b64_tr_b16 v[110:111], v11 offset:3328
    v_add_u32 v14, 0xfffe4000, v14
    ds_read_b64_tr_b16 v[250:251], v14 offset:0
    ds_read_b64_tr_b16 v[252:253], v14 offset:256
    v_dot2c_f32_bf16 v28, s70, v192
    v_dot2c_f32_bf16 v29, v192, v192
    buffer_load_dwordx2 v[44:45], off, s[32:35], 0 sc1
    s_add_u32 s67, s63, 147456
    buffer_load_dword v42, off, s[32:35], s67
    s_mul_i32 s67, s76, 28672
    buffer_load_dword v42, off, s[36:39], s67
    v_dot2c_f32_bf16 v28, s70, v193
    v_dot2c_f32_bf16 v29, v193, v193
    v_dot2c_f32_bf16 v28, s70, v194
    v_dot2c_f32_bf16 v29, v194, v194
    v_dot2c_f32_bf16 v28, s70, v195
    v_dot2c_f32_bf16 v29, v195, v195
    v_dot2c_f32_bf16 v28, s70, v196
    v_dot2c_f32_bf16 v29, v196, v196
    v_dot2c_f32_bf16 v28, s70, v197
    v_dot2c_f32_bf16 v29, v197, v197
    v_dot2c_f32_bf16 v28, s70, v198
    v_dot2c_f32_bf16 v29, v198, v198
    v_dot2c_f32_bf16 v28, s70, v199
    v_dot2c_f32_bf16 v29, v199, v199
    s_waitcnt lgkmcnt(0)
    s_waitcnt vmcnt(5)
    s_barrier
    v_mfma_f32_32x32x16_bf16 v[64:79], v[96:99], v[208:211], v[64:79]
    s_add_u32 m0, s90, 32768
    s_bfe_u32 s64, s53, 0x00040004
    s_mul_i32 s64, s64, 172032
    buffer_load_dwordx4 v8, s[12:15], s64 offen lds
    v_mfma_f32_16x16x32_bf16 v[56:59], v[240:243], v[250:253], v[56:59]
    ds_read_b128 v[224:227], v24 offset:32768
    ds_read_b64_tr_b16 v[80:81], v11 offset:8192
    ds_read_b64_tr_b16 v[82:83], v11 offset:8448
    ds_read_b128 v[228:231], v25 offset:32768
    v_mfma_f32_32x32x16_bf16 v[64:79], v[100:103], v[212:215], v[64:79]
    ds_read_b64_tr_b16 v[84:85], v11 offset:9216
    ds_read_b64_tr_b16 v[86:87], v11 offset:9472
    ds_read_b128 v[232:235], v26 offset:32768
    v_mfma_f32_32x32x16_bf16 v[64:79], v[104:107], v[216:219], v[64:79]
    s_add_u32 m0, s55, 36864
    s_bfe_u32 s64, s53, 0x00040004
    s_mul_i32 s64, s64, 229376
    buffer_load_dwordx4 v9, s[44:47], s64 offen lds
    ds_read_b64_tr_b16 v[88:89], v11 offset:10240
    ds_read_b64_tr_b16 v[90:91], v11 offset:10496
    ds_read_b128 v[236:239], v27 offset:32768
    ds_read_b64_tr_b16 v[92:93], v11 offset:11264
    v_mfma_f32_32x32x16_bf16 v[64:79], v[108:111], v[220:223], v[64:79]
    ds_read_b64_tr_b16 v[94:95], v11 offset:11520
    ds_read_b64_tr_b16 v[250:251], v14 offset:8192
    ds_read_b64_tr_b16 v[252:253], v14 offset:8448
    v_dot2c_f32_bf16 v28, s70, v208
    v_dot2c_f32_bf16 v29, v208, v208
    s_and_b32 s65, s54, 1024
    s_add_u32 m0, s65, 155648
    s_mul_i32 s64, s50, 1568
    s_add_u32 s64, s64, s65
    buffer_load_dwordx4 v2, s[40:43], s64 offen lds
    v_dot2c_f32_bf16 v28, s70, v209
    v_dot2c_f32_bf16 v29, v209, v209
    v_dot2c_f32_bf16 v28, s70, v210
    v_dot2c_f32_bf16 v29, v210, v210
    v_dot2c_f32_bf16 v28, s70, v211
    v_dot2c_f32_bf16 v29, v211, v211
    v_dot2c_f32_bf16 v28, s70, v212
    v_dot2c_f32_bf16 v29, v212, v212
    v_dot2c_f32_bf16 v28, s70, v213
    v_dot2c_f32_bf16 v29, v213, v213
    v_dot2c_f32_bf16 v28, s70, v214
    v_dot2c_f32_bf16 v29, v214, v214
    v_dot2c_f32_bf16 v28, s70, v215
    v_dot2c_f32_bf16 v29, v215, v215
    s_waitcnt lgkmcnt(0)
    s_waitcnt vmcnt(6)
    s_barrier
    v_mfma_f32_32x32x16_bf16 v[64:79], v[80:83], v[224:227], v[64:79]
    s_add_u32 m0, s90, 49152
    s_bfe_u32 s64, s53, 0x00040008
    s_mul_i32 s64, s64, 172032
    buffer_load_dwordx4 v8, s[12:15], s64 offen lds
    v_mfma_f32_16x16x32_bf16 v[56:59], v[240:243], v[250:253], v[56:59]
    v_mfma_f32_32x32x16_bf16 v[64:79], v[84:87], v[228:231], v[64:79]
    v_mfma_f32_32x32x16_bf16 v[64:79], v[88:91], v[232:235], v[64:79]
    v_mfma_f32_32x32x16_bf16 v[64:79], v[92:95], v[236:239], v[64:79]
    v_add_u32 v11, 0x00004000, v11
    ds_read_b64_tr_b16 v[112:113], v11 offset:0
    ds_read_b64_tr_b16 v[114:115], v11 offset:256
    ds_read_b64_tr_b16 v[116:117], v12 offset:0
    ds_read_b64_tr_b16 v[118:119], v13 offset:0
    ds_read_b64_tr_b16 v[120:121], v11 offset:1024
    ds_read_b64_tr_b16 v[122:123], v11 offset:1280
    v_dot2c_f32_bf16 v28, s70, v224
    v_dot2c_f32_bf16 v29, v224, v224
    v_dot2c_f32_bf16 v28, s70, v225
    s_add_u32 m0, s55, 53248
    s_bfe_u32 s64, s53, 0x00040008
    s_mul_i32 s64, s64, 229376
    buffer_load_dwordx4 v9, s[44:47], s64 offen lds
    v_dot2c_f32_bf16 v29, v225, v225
    v_dot2c_f32_bf16 v28, s70, v226
    v_dot2c_f32_bf16 v29, v226, v226
    v_dot2c_f32_bf16 v28, s70, v227
    v_dot2c_f32_bf16 v29, v227, v227
    v_dot2c_f32_bf16 v28, s70, v228
    v_dot2c_f32_bf16 v29, v228, v228
    v_dot2c_f32_bf16 v28, s70, v229
    v_dot2c_f32_bf16 v29, v229, v229
    v_dot2c_f32_bf16 v28, s70, v230
    v_dot2c_f32_bf16 v29, v230, v230
    v_dot2c_f32_bf16 v28, s70, v231
    v_dot2c_f32_bf16 v29, v231, v231
    s_waitcnt lgkmcnt(4)
    v_mfma_f32_32x32x16_bf16 v[80:95], v[112:115], v[128:131], 0
    ds_read_b64_tr_b16 v[124:125], v12 offset:1536
    ds_read_b64_tr_b16 v[126:127], v13 offset:1536
    v_lshrrev_b32 v30, 1, v2
    s_lshr_b32 s65, s54, 1
    s_add_u32 s65, s65, 159744
    v_add_u32 v30, s65, v30
    s_mov_b32 s83, 0x07060302
    v_and_b32 v255, 31, v1
    v_lshlrev_b32 v255, 4, v255
    v_add_u32 v255, 157696, v255
    s_lshl_b32 s65, s58, 2
    v_add_u32 v254, s65, v255
    ds_write_b64 v30, v[28:29]
    ds_write_b32 v254, v56
    v_xor_b32 v30, 2048, v30
    s_waitcnt vmcnt(7)
    v_readfirstlane_b32 s56, v44
    v_readfirstlane_b32 s57, v45
    s_nop 0
    s_add_u32 s56, s56, 0x9e3779b9
    s_add_u32 s57, s57, 0x7f4a7c15
    s_waitcnt vmcnt(5)
    v_mov_b32 v42, 0
    s_waitcnt lgkmcnt(6)
    v_mfma_f32_32x32x16_bf16 v[96:111], v[116:119], v[128:131], 0
    ds_read_b64_tr_b16 v[112:113], v11 offset:2048
    ds_read_b64_tr_b16 v[114:115], v11 offset:2304
    v_add_u32 v14, 0x00004000, v14
    ds_read_b64_tr_b16 v[250:251], v14 offset:0
    ds_read_b64_tr_b16 v[252:253], v14 offset:256
    v_bfe_u32 v24, v1, 2, 2
    v_lshrrev_b32 v25, 5, v1
    v_bfe_u32 v26, v1, 4, 1
    v_and_b32 v27, 3, v1
    s_waitcnt lgkmcnt(8)
    v_mfma_f32_32x32x16_bf16 v[80:95], v[120:123], v[132:135], v[80:95]
    ds_read_b64_tr_b16 v[116:117], v12 offset:3072
    ds_read_b64_tr_b16 v[118:119], v13 offset:3072
    v_lshl_or_b32 v26, v26, 2, v27
    v_subrev_u32 v27, 1, v26
    v_mul_u32_u24 v44, 56, v24
    v_cmp_lt_u32 vcc, 5, v26
    s_nop 1
    v_cndmask_b32 v26, v26, v27, vcc
    s_waitcnt lgkmcnt(8)
    v_mfma_f32_32x32x16_bf16 v[96:111], v[124:127], v[132:135], v[96:111]
    s_waitcnt lgkmcnt(2)
    v_mfma_f32_16x16x32_bf16 v[56:59], v[240:243], v[250:253], 0
    ds_read_b64_tr_b16 v[120:121], v11 offset:3072
    ds_read_b64_tr_b16 v[122:123], v11 offset:3328
    ds_read_b64_tr_b16 v[250:251], v15 offset:0
    ds_read_b64_tr_b16 v[252:253], v16 offset:0
    v_lshl_add_u32 v44, v26, 3, v44
    v_add_u32 v44, 155648, v44
    v_mul_u32_u24 v45, 224, v25
    v_mfma_f32_32x32x16_bf16 v[80:95], v[112:115], v[136:139], v[80:95]
    ds_read_b64_tr_b16 v[124:125], v12 offset:4608
    ds_read_b64_tr_b16 v[126:127], v13 offset:4608
    v_add_u32 v45, v44, v45
    v_and_b32 v24, 31, v1
    s_lshl_b32 s66, s58, 5
    v_add_u32 v24, s66, v24
    v_and_b32 v26, 9, v1
    s_waitcnt vmcnt(2)
    s_barrier
    s_waitcnt lgkmcnt(6)
    v_mfma_f32_32x32x16_bf16 v[96:111], v[116:119], v[136:139], v[96:111]
    s_waitcnt lgkmcnt(2)
    v_mfma_f32_16x16x32_bf16 v[60:63], v[240:243], v[250:253], 0
    v_add_u32 v11, 0x00004000, v11
    ds_read_b64_tr_b16 v[112:113], v11 offset:0
    ds_read_b64_tr_b16 v[114:115], v11 offset:256
    ds_read_b64 v[30:31], v30
    v_bfe_u32 v27, v1, 1, 1
    v_lshl_or_b32 v26, v27, 2, v26
    v_bfe_u32 v27, v1, 2, 1
    v_lshl_or_b32 v26, v27, 1, v26
    v_mfma_f32_32x32x16_bf16 v[80:95], v[120:123], v[140:143], v[80:95]
    ds_read_b64_tr_b16 v[116:117], v12 offset:16384
    ds_read_b64_tr_b16 v[118:119], v13 offset:16384
    v_xor_b32 v46, v26, v25
    v_lshlrev_b32 v47, 7, v24
    v_add_u32 v47, 139264, v47
    s_waitcnt lgkmcnt(5)
    v_mfma_f32_32x32x16_bf16 v[96:111], v[124:127], v[140:143], v[96:111]
    ds_read_b64_tr_b16 v[120:121], v11 offset:1024
    ds_read_b64_tr_b16 v[122:123], v11 offset:1280
    s_waitcnt lgkmcnt(4)
    v_add_f32 v28, v28, v30
    v_add_f32 v29, v29, v31
    s_nop 1
    v_permlane32_swap_b32 v28, v29
    v_add_f32 v28, v28, v29
    v_mul_f32 v28, 0x3b124925, v28
    v_mov_b32 v29, v28
    s_nop 1
    v_permlane32_swap_b32 v28, v29
    v_mfma_f32_32x32x16_bf16 v[80:95], v[112:115], v[144:147], v[80:95]
    ds_read_b64_tr_b16 v[124:125], v12 offset:17920
    ds_read_b64_tr_b16 v[126:127], v13 offset:17920
    v_fma_f32 v29, -v28, v28, v29
    v_max_f32 v29, 0, v29
    v_sub_f32 v28, 0, v28
    v_cvt_pk_bf16_f32 v30, v28, v29
    v_and_b32 v29, 0xffff0000, v30
    v_add_f32 v29, 0x3727c5ac, v29
    v_and_b32 v30, 0xffff, v30
    v_cvt_pk_bf16_f32 v29, v29, v29
    s_waitcnt lgkmcnt(4)
    v_mfma_f32_32x32x16_bf16 v[96:111], v[116:119], v[144:147], v[96:111]
    ds_read_b64_tr_b16 v[112:113], v11 offset:2048
    ds_read_b64_tr_b16 v[114:115], v11 offset:2304
    v_cmp_gt_u32 vcc, 32, v1
    v_and_b32 v29, 0xffff0000, v29
    v_sqrt_f32 v29, v29
    v_cndmask_b32 v247, 0, v30, vcc
    v_cvt_pk_bf16_f32 v29, v29, v29
    v_lshl_or_b32 v246, v247, 16, v247
    v_and_b32 v29, 0xffff0000, v29
    ds_read_b128 v[250:253], v255 offset:0
    s_waitcnt lgkmcnt(5)
    v_mfma_f32_32x32x16_bf16 v[80:95], v[120:123], v[148:151], v[80:95]
    ds_read_b64_tr_b16 v[116:117], v12 offset:19456
    ds_read_b64_tr_b16 v[118:119], v13 offset:19456
    v_rcp_f32 v28, v29
    v_mul_f32 v4, v29, v29
    v_mul_f32 v5, 0x3fb8aa3b, v28
    v_mul_f32 v6, 0xc0135761, v28
    v_mul_f32 v30, v28, v28
    v_mul_f32 v7, 0x3d372713, v6
    v_mul_f32 v7, v7, v30
    s_waitcnt lgkmcnt(5)
    v_mfma_f32_32x32x16_bf16 v[96:111], v[124:127], v[148:151], v[96:111]
    ds_read_b64_tr_b16 v[120:121], v11 offset:3072
    ds_read_b64_tr_b16 v[122:123], v11 offset:3328
    s_waitcnt lgkmcnt(4)
    v_add_f32 v250, v250, v251
    v_add_f32 v252, v252, v253
    v_add_f32 v250, v250, v252
    v_and_b32 v251, 0xffff0000, v250
    v_sub_f32 v251, v250, v251
    v_and_b32 v252, 0xffff0000, v251
    v_perm_b32 v244, v251, v250, s83
    v_sub_f32 v252, v251, v252
    v_lshrrev_b32 v245, 16, v252
    v_mov_b32 v30, v44
    v_mov_b32 v31, v45
    v_mov_b32 v28, v46
    v_mov_b32 v29, v47
    ds_read_b64_tr_b16 v[48:49], v31
    ds_read_b64_tr_b16 v[50:51], v31 offset:448
    ds_read_b64_tr_b16 v[52:53], v31 offset:896
    ds_read_b64_tr_b16 v[54:55], v30 offset:1344
    v_mfma_f32_32x32x16_bf16 v[80:95], v[112:115], v[152:155], v[80:95]
    s_waitcnt vmcnt(0)
    s_barrier
    v_mfma_f32_32x32x16_bf16 v[64:79], v[244:247], v[246:249], v[64:79]
    ds_read_b64_tr_b16 v[124:125], v12 offset:20992
    ds_read_b64_tr_b16 v[126:127], v13 offset:20992
    v_add_u32 v14, 0x00004000, v14
    ds_read_b64_tr_b16 v[250:251], v14 offset:0
    ds_read_b64_tr_b16 v[252:253], v14 offset:256
    s_waitcnt lgkmcnt(10)
    v_mfma_f32_32x32x16_bf16 v[96:111], v[116:119], v[152:155], v[96:111]
    v_add_u32 v11, 0x00004000, v11
    ds_read_b64_tr_b16 v[112:113], v11 offset:0
    ds_read_b64_tr_b16 v[114:115], v11 offset:256
    s_waitcnt lgkmcnt(10)
    v_mfma_f32_32x32x16_bf16 v[80:95], v[120:123], v[156:159], v[80:95]
    s_waitcnt lgkmcnt(2)
    v_mfma_f32_16x16x32_bf16 v[56:59], v[240:243], v[250:253], v[56:59]
    ds_read_b64_tr_b16 v[116:117], v12 offset:32768
    ds_read_b64_tr_b16 v[118:119], v13 offset:32768
    ds_read_b64_tr_b16 v[250:251], v15 offset:16384
    ds_read_b64_tr_b16 v[252:253], v16 offset:16384
    v_mfma_f32_32x32x16_bf16 v[96:111], v[124:127], v[156:159], v[96:111]
    ds_read_b64_tr_b16 v[120:121], v11 offset:1024
    ds_read_b64_tr_b16 v[122:123], v11 offset:1280
    v_cmp_lt_u32 vcc, 31, v1
    s_nop 1
    v_cndmask_b32 v54, 0, v54, vcc
    v_cndmask_b32 v55, 0, v55, vcc
    v_cvt_pk_bf16_f32 v64, v64, v65
    v_cvt_pk_bf16_f32 v65, v66, v67
    v_cvt_pk_bf16_f32 v66, v68, v69
    v_cvt_pk_bf16_f32 v67, v70, v71
    v_cvt_pk_bf16_f32 v68, v72, v73
    v_cvt_pk_bf16_f32 v69, v74, v75
    v_cvt_pk_bf16_f32 v70, v76, v77
    v_cvt_pk_bf16_f32 v71, v78, v79
    v_mfma_f32_32x32x16_bf16 v[32:47], v[48:51], v[64:67], 0
    s_waitcnt lgkmcnt(6)
    v_mfma_f32_32x32x16_bf16 v[80:95], v[112:115], v[160:163], v[80:95]
    s_waitcnt lgkmcnt(2)
    v_mfma_f32_16x16x32_bf16 v[60:63], v[240:243], v[250:253], v[60:63]
    ds_read_b64_tr_b16 v[124:125], v12 offset:34304
    ds_read_b64_tr_b16 v[126:127], v13 offset:34304
    v_add_u32 v14, 0x00004000, v14
    ds_read_b64_tr_b16 v[250:251], v14 offset:0
    ds_read_b64_tr_b16 v[252:253], v14 offset:256
    v_mfma_f32_32x32x16_bf16 v[32:47], v[52:55], v[68:71], v[32:47]
    v_mfma_f32_32x32x16_bf16 v[96:111], v[116:119], v[160:163], v[96:111]
    ds_read_b64_tr_b16 v[112:113], v11 offset:2048
    ds_read_b64_tr_b16 v[114:115], v11 offset:2304
    s_waitcnt lgkmcnt(6)
    v_mfma_f32_32x32x16_bf16 v[80:95], v[120:123], v[164:167], v[80:95]
    s_waitcnt lgkmcnt(2)
    v_mfma_f32_16x16x32_bf16 v[56:59], v[240:243], v[250:253], v[56:59]
    ds_read_b64_tr_b16 v[116:117], v12 offset:35840
    ds_read_b64_tr_b16 v[118:119], v13 offset:35840
    ds_read_b64_tr_b16 v[250:251], v15 offset:32768
    ds_read_b64_tr_b16 v[252:253], v16 offset:32768
    s_nop 0
    v_max3_f32 v24, v32, v33, v34
    v_max3_f32 v25, -v32, -v33, -v34
    v_max3_f32 v26, v35, v36, v37
    v_max3_f32 v27, -v35, -v36, -v37
    v_max3_f32 v24, v24, v38, v39
    v_max3_f32 v25, v25, -v38, -v39
    v_max3_f32 v26, v26, v40, v41
    v_max3_f32 v27, v27, -v40, -v41
    v_max3_f32 v24, v24, v42, v43
    v_max3_f32 v25, v25, -v42, -v43
    v_max3_f32 v26, v26, v44, v45
    v_max3_f32 v27, v27, -v44, -v45
    v_max3_f32 v24, v24, v46, v47
    v_mfma_f32_32x32x16_bf16 v[96:111], v[124:127], v[164:167], v[96:111]
    ds_read_b64_tr_b16 v[120:121], v11 offset:3072
    ds_read_b64_tr_b16 v[122:123], v11 offset:3328
    v_max3_f32 v25, v25, -v46, -v47
    v_max_f32 v24, v24, v26
    v_max_f32 v25, v25, v27
    s_nop 1
    v_permlane32_swap_b32 v24, v25
    v_max_f32 v24, v24, v25
    v_mul_f32_e64 v24, -v5, v24
    v_mov_b32 v25, v24
    s_nop 1
    v_permlane32_swap_b32 v24, v25
    v_fma_f32 v64, v32, v5, v24
    v_fma_f32 v32, -v32, v5, v25
    s_waitcnt lgkmcnt(6)
    v_mfma_f32_32x32x16_bf16 v[80:95], v[112:115], v[168:171], v[80:95]
    s_barrier
    s_waitcnt lgkmcnt(2)
    v_mfma_f32_16x16x32_bf16 v[60:63], v[240:243], v[250:253], v[60:63]
    ds_read_b64_tr_b16 v[124:125], v12 offset:37376
    ds_read_b64_tr_b16 v[126:127], v13 offset:37376
    v_fma_f32 v65, v33, v5, v24
    v_fma_f32 v33, -v33, v5, v25
    v_exp_f32 v64, v64
    v_exp_f32 v32, v32
    v_fma_f32 v66, v34, v5, v24
    v_fma_f32 v34, -v34, v5, v25
    v_exp_f32 v65, v65
    v_exp_f32 v33, v33
    v_fma_f32 v67, v35, v5, v24
    v_mfma_f32_32x32x16_bf16 v[96:111], v[116:119], v[168:171], v[96:111]
    v_add_u32 v11, 0x00004000, v11
    ds_read_b64_tr_b16 v[112:113], v11 offset:0
    ds_read_b64_tr_b16 v[114:115], v11 offset:256
    v_add_u32 v14, 0x00004000, v14
    ds_read_b64_tr_b16 v[250:251], v14 offset:0
    ds_read_b64_tr_b16 v[252:253], v14 offset:256
    v_fma_f32 v35, -v35, v5, v25
    v_exp_f32 v66, v66
    v_exp_f32 v34, v34
    v_fma_f32 v68, v36, v5, v24
    v_fma_f32 v36, -v36, v5, v25
    v_exp_f32 v67, v67
    v_exp_f32 v35, v35
    v_fma_f32 v69, v37, v5, v24
    s_waitcnt lgkmcnt(6)
    v_mfma_f32_32x32x16_bf16 v[80:95], v[120:123], v[172:175], v[80:95]
    ds_read_b64_tr_b16 v[116:117], v12 offset:49152
    ds_read_b64_tr_b16 v[118:119], v13 offset:49152
    v_fma_f32 v37, -v37, v5, v25
    v_exp_f32 v68, v68
    v_exp_f32 v36, v36
    v_fma_f32 v70, v38, v5, v24
    v_fma_f32 v38, -v38, v5, v25
    v_exp_f32 v69, v69
    v_exp_f32 v37, v37
    v_fma_f32 v71, v39, v5, v24
    v_fma_f32 v39, -v39, v5, v25
    s_waitcnt lgkmcnt(6)
    v_mfma_f32_32x32x16_bf16 v[96:111], v[124:127], v[172:175], v[96:111]
    s_waitcnt lgkmcnt(2)
    v_mfma_f32_16x16x32_bf16 v[56:59], v[240:243], v[250:253], v[56:59]
    ds_read_b64_tr_b16 v[120:121], v11 offset:1024
    ds_read_b64_tr_b16 v[122:123], v11 offset:1280
    ds_read_b64_tr_b16 v[250:251], v15 offset:49152
    ds_read_b64_tr_b16 v[252:253], v16 offset:49152
    v_exp_f32 v70, v70
    v_exp_f32 v38, v38
    v_fma_f32 v72, v40, v5, v24
    v_fma_f32 v40, -v40, v5, v25
    v_exp_f32 v71, v71
    v_exp_f32 v39, v39
    v_fma_f32 v73, v41, v5, v24
    v_fma_f32 v41, -v41, v5, v25
    v_mfma_f32_32x32x16_bf16 v[80:95], v[112:115], v[176:179], v[80:95]
    ds_read_b64_tr_b16 v[124:125], v12 offset:50688
    ds_read_b64_tr_b16 v[126:127], v13 offset:50688
    v_exp_f32 v72, v72
    v_exp_f32 v40, v40
    v_fma_f32 v74, v42, v5, v24
    v_fma_f32 v42, -v42, v5, v25
    v_exp_f32 v73, v73
    v_exp_f32 v41, v41
    v_fma_f32 v75, v43, v5, v24
    v_fma_f32 v43, -v43, v5, v25
    s_waitcnt lgkmcnt(6)
    v_mfma_f32_32x32x16_bf16 v[96:111], v[116:119], v[176:179], v[96:111]
    s_waitcnt lgkmcnt(2)
    v_mfma_f32_16x16x32_bf16 v[60:63], v[240:243], v[250:253], v[60:63]
    ds_read_b64_tr_b16 v[112:113], v11 offset:2048
    ds_read_b64_tr_b16 v[114:115], v11 offset:2304
    v_exp_f32 v74, v74
    v_exp_f32 v42, v42
    v_fma_f32 v76, v44, v5, v24
    v_fma_f32 v44, -v44, v5, v25
    v_exp_f32 v75, v75
    v_exp_f32 v43, v43
    v_fma_f32 v77, v45, v5, v24
    v_fma_f32 v45, -v45, v5, v25
    v_exp_f32 v76, v76
    v_mfma_f32_32x32x16_bf16 v[80:95], v[120:123], v[180:183], v[80:95]
    ds_read_b64_tr_b16 v[116:117], v12 offset:52224
    ds_read_b64_tr_b16 v[118:119], v13 offset:52224
    v_exp_f32 v44, v44
    v_fma_f32 v78, v46, v5, v24
    v_fma_f32 v46, -v46, v5, v25
    v_exp_f32 v77, v77
    v_exp_f32 v45, v45
    v_fma_f32 v79, v47, v5, v24
    v_fma_f32 v47, -v47, v5, v25
    v_exp_f32 v78, v78
    s_waitcnt lgkmcnt(4)
    v_mfma_f32_32x32x16_bf16 v[96:111], v[124:127], v[180:183], v[96:111]
    ds_read_b64_tr_b16 v[120:121], v11 offset:3072
    ds_read_b64_tr_b16 v[122:123], v11 offset:3328
    v_exp_f32 v46, v46
    v_exp_f32 v79, v79
    v_exp_f32 v47, v47
    v_add_f32 v24, v64, v65
    v_add_f32 v25, v32, v33
    v_add_f32 v26, v76, v77
    v_add_f32 v27, v44, v45
    v_add_f32 v24, v24, v66
    v_add_f32 v25, v25, v34
    s_waitcnt lgkmcnt(4)
    v_mfma_f32_32x32x16_bf16 v[80:95], v[112:115], v[184:187], v[80:95]
    s_barrier
    ds_read_b64_tr_b16 v[124:125], v12 offset:53760
    ds_read_b64_tr_b16 v[126:127], v13 offset:53760
    v_add_f32 v26, v26, v78
    v_add_f32 v27, v27, v46
    v_add_f32 v24, v24, v67
    v_add_f32 v25, v25, v35
    v_add_f32 v26, v26, v79
    v_add_f32 v27, v27, v47
    v_add_f32 v24, v24, v68
    v_add_f32 v25, v25, v36
    v_add_f32 v24, v24, v69
    v_add_f32 v25, v25, v37
    v_add_f32 v24, v24, v70
    v_add_f32 v25, v25, v38
    s_waitcnt lgkmcnt(4)
    v_mfma_f32_32x32x16_bf16 v[96:111], v[116:119], v[184:187], v[96:111]
    v_add_u32 v11, 0x00004000, v11
    ds_read_b64_tr_b16 v[112:113], v11 offset:0
    ds_read_b64_tr_b16 v[114:115], v11 offset:256
    v_add_u32 v14, 0x00004000, v14
    ds_read_b64_tr_b16 v[250:251], v14 offset:0
    ds_read_b64_tr_b16 v[252:253], v14 offset:256
    v_add_f32 v24, v24, v71
    v_add_f32 v25, v25, v39
    v_add_f32 v24, v24, v72
    v_add_f32 v25, v25, v40
    v_add_f32 v24, v24, v73
    v_add_f32 v25, v25, v41
    v_add_f32 v24, v24, v74
    v_add_f32 v25, v25, v42
    v_add_f32 v24, v24, v75
    v_add_f32 v25, v25, v43
    v_fmac_f32 v24, v26, v3
    v_fmac_f32 v25, v27, v3
    s_waitcnt lgkmcnt(6)
    v_mfma_f32_32x32x16_bf16 v[80:95], v[120:123], v[188:191], v[80:95]
    v_add_u32 v12, 0x00010000, v12
    v_add_u32 v13, 0x00010000, v13
    ds_read_b64_tr_b16 v[116:117], v12 offset:0
    ds_read_b64_tr_b16 v[118:119], v13 offset:0
    v_permlane32_swap_b32 v24, v25
    v_add_f32 v24, v24, v25
    v_mul_f32 v24, 0x3fb8aa3b, v24
    v_rcp_f32 v24, v24
    s_nop 0
    v_mul_f32 v24, v24, v5
    v_mov_b32 v25, v24
    s_nop 1
    v_permlane32_swap_b32 v24, v25
    v_mul_f32 v26, v24, v3
    v_mul_f32 v27, v25, v3
    v_mul_f32 v64, v64, v24
    s_waitcnt lgkmcnt(6)
    v_mfma_f32_32x32x16_bf16 v[96:111], v[124:127], v[188:191], v[96:111]
    s_waitcnt lgkmcnt(2)
    v_mfma_f32_16x16x32_bf16 v[56:59], v[240:243], v[250:253], v[56:59]
    ds_read_b64_tr_b16 v[120:121], v11 offset:1024
    ds_read_b64_tr_b16 v[122:123], v11 offset:1280
    v_add_u32 v15, 0x00010000, v15
    v_add_u32 v16, 0x00010000, v16
    ds_read_b64_tr_b16 v[250:251], v15 offset:0
    ds_read_b64_tr_b16 v[252:253], v16 offset:0
    v_mul_f32 v65, v65, v24
    v_mul_f32 v32, v32, v25
    v_mul_f32 v33, v33, v25
    v_cvt_pk_bf16_f32 v64, v64, v65
    v_cvt_pk_bf16_f32 v32, v32, v33
    v_mul_f32 v66, v66, v24
    v_mul_f32 v67, v67, v24
    v_mul_f32 v34, v34, v25
    v_mul_f32 v35, v35, v25
    v_cvt_pk_bf16_f32 v65, v66, v67
    v_cvt_pk_bf16_f32 v33, v34, v35
    v_mul_f32 v68, v68, v24
    v_mfma_f32_32x32x16_bf16 v[80:95], v[112:115], v[192:195], v[80:95]
    ds_read_b64_tr_b16 v[124:125], v12 offset:1536
    ds_read_b64_tr_b16 v[126:127], v13 offset:1536
    v_mul_f32 v69, v69, v24
    v_mul_f32 v36, v36, v25
    v_mul_f32 v37, v37, v25
    v_cvt_pk_bf16_f32 v66, v68, v69
    v_cvt_pk_bf16_f32 v34, v36, v37
    v_mul_f32 v70, v70, v24
    v_mul_f32 v71, v71, v24
    v_mul_f32 v38, v38, v25
    v_mul_f32 v39, v39, v25
    v_cvt_pk_bf16_f32 v67, v70, v71
    v_cvt_pk_bf16_f32 v35, v38, v39
    v_mul_f32 v72, v72, v24
    v_mul_f32 v73, v73, v24
    s_waitcnt lgkmcnt(6)
    v_mfma_f32_32x32x16_bf16 v[96:111], v[116:119], v[192:195], v[96:111]
    s_waitcnt lgkmcnt(2)
    v_mfma_f32_16x16x32_bf16 v[60:63], v[240:243], v[250:253], v[60:63]
    ds_read_b64_tr_b16 v[112:113], v11 offset:2048
    ds_read_b64_tr_b16 v[114:115], v11 offset:2304
    v_mul_f32 v40, v40, v25
    v_mul_f32 v41, v41, v25
    v_cvt_pk_bf16_f32 v68, v72, v73
    v_cvt_pk_bf16_f32 v36, v40, v41
    v_mul_f32 v74, v74, v24
    v_mul_f32 v75, v75, v24
    v_mul_f32 v42, v42, v25
    v_mul_f32 v43, v43, v25
    v_cvt_pk_bf16_f32 v69, v74, v75
    v_cvt_pk_bf16_f32 v37, v42, v43
    v_mul_f32 v76, v76, v26
    v_mul_f32 v77, v77, v26
    v_mfma_f32_32x32x16_bf16 v[80:95], v[120:123], v[196:199], v[80:95]
    ds_read_b64_tr_b16 v[116:117], v12 offset:3072
    ds_read_b64_tr_b16 v[118:119], v13 offset:3072
    v_mul_f32 v44, v44, v27
    v_mul_f32 v45, v45, v27
    v_cvt_pk_bf16_f32 v70, v76, v77
    v_cvt_pk_bf16_f32 v38, v44, v45
    v_mul_f32 v78, v78, v26
    v_mul_f32 v79, v79, v26
    v_mul_f32 v46, v46, v27
    v_mul_f32 v47, v47, v27
    v_cvt_pk_bf16_f32 v71, v78, v79
    v_cvt_pk_bf16_f32 v39, v46, v47
    v_xor_b32 v23, 0, v28
    v_lshl_add_u32 v23, v23, 3, v29
    s_waitcnt lgkmcnt(4)
    v_mfma_f32_32x32x16_bf16 v[96:111], v[124:127], v[196:199], v[96:111]
    ds_read_b64_tr_b16 v[120:121], v11 offset:3072
    ds_read_b64_tr_b16 v[122:123], v11 offset:3328
    ds_write_b64 v23, v[64:65]
    v_xor_b32 v23, 2, v28
    v_lshl_add_u32 v23, v23, 3, v29
    ds_write_b64 v23, v[66:67]
    v_xor_b32 v23, 4, v28
    v_lshl_add_u32 v23, v23, 3, v29
    ds_write_b64 v23, v[68:69]
    v_xor_b32 v23, 6, v28
    v_lshl_add_u32 v23, v23, 3, v29
    ds_write_b64 v23, v[70:71]
    v_xor_b32 v23, 8, v28
    v_lshl_add_u32 v23, v23, 3, v29
    ds_write_b64 v23, v[32:33]
    s_waitcnt lgkmcnt(9)
    v_mfma_f32_32x32x16_bf16 v[80:95], v[112:115], v[200:203], v[80:95]
    ds_read_b64_tr_b16 v[124:125], v12 offset:4608
    ds_read_b64_tr_b16 v[126:127], v13 offset:4608
    v_xor_b32 v23, 10, v28
    v_lshl_add_u32 v23, v23, 3, v29
    ds_write_b64 v23, v[34:35]
    v_xor_b32 v23, 12, v28
    v_lshl_add_u32 v23, v23, 3, v29
    ds_write_b64 v23, v[36:37]
    v_xor_b32 v23, 14, v28
    v_lshl_add_u32 v23, v23, 3, v29
    ds_write_b64 v23, v[38:39]
    s_waitcnt lgkmcnt(0)
    s_barrier
    v_mfma_f32_32x32x16_bf16 v[96:111], v[116:119], v[200:203], v[96:111]
    v_add_u32 v11, 0x00004000, v11
    ds_read_b64_tr_b16 v[112:113], v11 offset:0
    ds_read_b64_tr_b16 v[114:115], v11 offset:256
    v_add_u32 v14, 0x00004000, v14
    ds_read_b64_tr_b16 v[250:251], v14 offset:0
    ds_read_b64_tr_b16 v[252:253], v14 offset:256
    v_mfma_f32_32x32x16_bf16 v[80:95], v[120:123], v[204:207], v[80:95]
    ds_read_b64_tr_b16 v[116:117], v12 offset:16384
    ds_read_b64_tr_b16 v[118:119], v13 offset:16384
    v_mfma_f32_32x32x16_bf16 v[96:111], v[124:127], v[204:207], v[96:111]
    s_waitcnt lgkmcnt(2)
    v_mfma_f32_16x16x32_bf16 v[56:59], v[240:243], v[250:253], v[56:59]
    ds_read_b64_tr_b16 v[120:121], v11 offset:1024
    ds_read_b64_tr_b16 v[122:123], v11 offset:1280
    ds_read_b64_tr_b16 v[250:251], v15 offset:16384
    ds_read_b64_tr_b16 v[252:253], v16 offset:16384
    v_mfma_f32_32x32x16_bf16 v[80:95], v[112:115], v[208:211], v[80:95]
    ds_read_b64_tr_b16 v[124:125], v12 offset:17920
    ds_read_b64_tr_b16 v[126:127], v13 offset:17920
    s_waitcnt lgkmcnt(6)
    v_mfma_f32_32x32x16_bf16 v[96:111], v[116:119], v[208:211], v[96:111]
    s_waitcnt lgkmcnt(2)
    v_mfma_f32_16x16x32_bf16 v[60:63], v[240:243], v[250:253], v[60:63]
    ds_read_b64_tr_b16 v[112:113], v11 offset:2048
    ds_read_b64_tr_b16 v[114:115], v11 offset:2304
    v_mfma_f32_32x32x16_bf16 v[80:95], v[120:123], v[212:215], v[80:95]
    ds_read_b64_tr_b16 v[116:117], v12 offset:19456
    ds_read_b64_tr_b16 v[118:119], v13 offset:19456
    s_waitcnt lgkmcnt(4)
    v_mfma_f32_32x32x16_bf16 v[96:111], v[124:127], v[212:215], v[96:111]
    ds_read_b64_tr_b16 v[120:121], v11 offset:3072
    ds_read_b64_tr_b16 v[122:123], v11 offset:3328
    s_waitcnt lgkmcnt(4)
    v_mfma_f32_32x32x16_bf16 v[80:95], v[112:115], v[216:219], v[80:95]
    s_barrier
    ds_read_b64_tr_b16 v[124:125], v12 offset:20992
    ds_read_b64_tr_b16 v[126:127], v13 offset:20992
    s_waitcnt lgkmcnt(4)
    v_mfma_f32_32x32x16_bf16 v[96:111], v[116:119], v[216:219], v[96:111]
    v_add_u32 v11, 0x00004000, v11
    ds_read_b64_tr_b16 v[112:113], v11 offset:0
    ds_read_b64_tr_b16 v[114:115], v11 offset:256
    v_add_u32 v14, 0x00004000, v14
    ds_read_b64_tr_b16 v[250:251], v14 offset:0
    ds_read_b64_tr_b16 v[252:253], v14 offset:256
    s_add_u32 m0, s90, 65536
    s_bfe_u32 s64, s53, 0x00040010
    s_mul_i32 s64, s64, 229376
    buffer_load_dwordx4 v17, s[16:19], s64 offen lds
    s_waitcnt lgkmcnt(6)
    v_mfma_f32_32x32x16_bf16 v[80:95], v[120:123], v[220:223], v[80:95]
    ds_read_b64_tr_b16 v[116:117], v12 offset:32768
    ds_read_b64_tr_b16 v[118:119], v13 offset:32768
    s_add_u32 m0, s90, 73728
    s_nop 0
    buffer_load_dwordx4 v18, s[20:23], s64 offen lds
    s_waitcnt lgkmcnt(6)
    v_mfma_f32_32x32x16_bf16 v[96:111], v[124:127], v[220:223], v[96:111]
    s_waitcnt lgkmcnt(2)
    v_mfma_f32_16x16x32_bf16 v[56:59], v[240:243], v[250:253], v[56:59]
    ds_read_b64_tr_b16 v[120:121], v11 offset:1024
    ds_read_b64_tr_b16 v[122:123], v11 offset:1280
    ds_read_b64_tr_b16 v[250:251], v15 offset:32768
    ds_read_b64_tr_b16 v[252:253], v16 offset:32768
    v_mfma_f32_32x32x16_bf16 v[80:95], v[112:115], v[224:227], v[80:95]
    ds_read_b64_tr_b16 v[124:125], v12 offset:34304
    ds_read_b64_tr_b16 v[126:127], v13 offset:34304
    s_add_u32 m0, s90, 69632
    s_add_u32 s64, s64, 114688
    buffer_load_dwordx4 v17, s[16:19], s64 offen lds
    s_waitcnt lgkmcnt(6)
    v_mfma_f32_32x32x16_bf16 v[96:111], v[116:119], v[224:227], v[96:111]
    s_waitcnt lgkmcnt(2)
    v_mfma_f32_16x16x32_bf16 v[60:63], v[240:243], v[250:253], v[60:63]
    ds_read_b64_tr_b16 v[112:113], v11 offset:2048
    ds_read_b64_tr_b16 v[114:115], v11 offset:2304
    v_mfma_f32_32x32x16_bf16 v[80:95], v[120:123], v[228:231], v[80:95]
    ds_read_b64_tr_b16 v[116:117], v12 offset:35840
    ds_read_b64_tr_b16 v[118:119], v13 offset:35840
    s_add_u32 m0, s90, 77824
    s_nop 0
    buffer_load_dwordx4 v18, s[20:23], s64 offen lds
    s_waitcnt lgkmcnt(4)
    v_mfma_f32_32x32x16_bf16 v[96:111], v[124:127], v[228:231], v[96:111]
    ds_read_b64_tr_b16 v[120:121], v11 offset:3072
    ds_read_b64_tr_b16 v[122:123], v11 offset:3328
    ds_write_b32 v254, v56 offset:0
    ds_write_b32 v254, v60 offset:512
    s_waitcnt lgkmcnt(6)
    v_mfma_f32_32x32x16_bf16 v[80:95], v[112:115], v[232:235], v[80:95]
    ds_read_b64_tr_b16 v[124:125], v12 offset:37376
    ds_read_b64_tr_b16 v[126:127], v13 offset:37376
    s_waitcnt lgkmcnt(2)
    s_barrier
    v_mfma_f32_32x32x16_bf16 v[96:111], v[116:119], v[232:235], v[96:111]
    ds_read_b64_tr_b16 v[112:113], v20 offset:0
    ds_read_b64_tr_b16 v[114:115], v20 offset:512
    ds_read_b128 v[250:253], v255 offset:0
    s_add_u32 m0, s90, 81920
    s_bfe_u32 s64, s53, 0x00040014
    s_mul_i32 s64, s64, 229376
    buffer_load_dwordx4 v17, s[16:19], s64 offen lds
    s_add_u32 m0, s90, 90112
    s_nop 0
    buffer_load_dwordx4 v18, s[20:23], s64 offen lds
    v_mfma_f32_32x32x16_bf16 v[80:95], v[120:123], v[236:239], v[80:95]
    ds_read_b64_tr_b16 v[116:117], v21 offset:0
    ds_read_b64_tr_b16 v[118:119], v21 offset:512
    s_add_u32 m0, s90, 86016
    s_add_u32 s64, s64, 114688
    buffer_load_dwordx4 v17, s[16:19], s64 offen lds
    s_waitcnt lgkmcnt(5)
    v_mfma_f32_32x32x16_bf16 v[96:111], v[124:127], v[236:239], v[96:111]
    ds_read_b64_tr_b16 v[120:121], v20 offset:2048
    ds_read_b64_tr_b16 v[122:123], v20 offset:2560
    s_waitcnt lgkmcnt(4)
    v_add_f32 v250, v250, v251
    v_add_f32 v252, v252, v253
    v_add_f32 v250, v250, v252
    v_and_b32 v251, 0xffff0000, v250
    v_sub_f32 v251, v250, v251
    v_and_b32 v252, 0xffff0000, v251
    v_perm_b32 v244, v251, v250, s83
    v_sub_f32 v252, v251, v252
    v_lshrrev_b32 v245, 16, v252
    s_add_u32 m0, s90, 94208
    s_nop 0
    buffer_load_dwordx4 v18, s[20:23], s64 offen lds
    s_add_u32 m0, s90, 131072
    s_mov_b32 s64, 57344
    buffer_load_dwordx4 v19, s[24:27], s64 offen lds
    v_mfma_f32_32x32x16_bf16 v[32:47], v[112:115], v[128:131], 0
    v_mfma_f32_32x32x16_bf16 v[80:95], v[244:247], v[246:249], v[80:95]
    ds_read_b64_tr_b16 v[124:125], v21 offset:2048
    ds_read_b64_tr_b16 v[126:127], v21 offset:2560
    ds_read_b128 v[250:253], v255 offset:512
    s_add_u32 m0, s90, 135168
    s_mov_b32 s64, 86016
    buffer_load_dwordx4 v19, s[24:27], s64 offen lds
    s_waitcnt lgkmcnt(5)
    v_mfma_f32_32x32x16_bf16 v[48:63], v[116:119], v[128:131], 0
    ds_read_b64_tr_b16 v[112:113], v20 offset:4096
    ds_read_b64_tr_b16 v[114:115], v20 offset:4608
    s_add_u32 m0, s90, 139264
    s_mov_b32 s64, 172032
    buffer_load_dwordx4 v19, s[24:27], s64 offen lds
    s_add_u32 m0, s90, 143360
    s_mov_b32 s64, 200704
    buffer_load_dwordx4 v19, s[24:27], s64 offen lds
    s_waitcnt lgkmcnt(5)
    v_mfma_f32_32x32x16_bf16 v[32:47], v[120:123], v[132:135], v[32:47]
    ds_read_b64_tr_b16 v[116:117], v21 offset:4096
    ds_read_b64_tr_b16 v[118:119], v21 offset:4608
    s_waitcnt lgkmcnt(4)
    v_add_f32 v250, v250, v251
    v_add_f32 v252, v252, v253
    v_add_f32 v250, v250, v252
    v_and_b32 v251, 0xffff0000, v250
    v_sub_f32 v251, v250, v251
    v_and_b32 v252, 0xffff0000, v251
    v_perm_b32 v244, v251, v250, s83
    v_sub_f32 v252, v251, v252
    v_lshrrev_b32 v245, 16, v252
    s_add_u32 m0, s90, 147456
    s_mov_b32 s64, 286720
    buffer_load_dwordx4 v19, s[24:27], s64 offen lds
    v_mfma_f32_32x32x16_bf16 v[48:63], v[124:127], v[132:135], v[48:63]
    v_mfma_f32_32x32x16_bf16 v[96:111], v[244:247], v[246:249], v[96:111]
    ds_read_b64_tr_b16 v[120:121], v20 offset:6144
    ds_read_b64_tr_b16 v[122:123], v20 offset:6656
    s_add_u32 m0, s90, 151552
    s_mov_b32 s64, 315392
    buffer_load_dwordx4 v19, s[24:27], s64 offen lds
    s_waitcnt lgkmcnt(4)
    v_mfma_f32_32x32x16_bf16 v[32:47], v[112:115], v[136:139], v[32:47]
    s_barrier
    ds_read_b64_tr_b16 v[124:125], v21 offset:6144
    ds_read_b64_tr_b16 v[126:127], v21 offset:6656
    s_lshl_b32 s67, s58, 11
    v_add_u32 v16, s67, v20
    ds_read_b64_tr_b16 v[250:251], v16 offset:0
    ds_read_b64_tr_b16 v[252:253], v16 offset:512
    s_waitcnt lgkmcnt(6)
    v_mfma_f32_32x32x16_bf16 v[48:63], v[116:119], v[136:139], v[48:63]
    ds_read_b64_tr_b16 v[112:113], v20 offset:16384
    ds_read_b64_tr_b16 v[114:115], v20 offset:16896
    s_add_u32 m0, s90, 98304
    s_bfe_u32 s64, s53, 0x00040018
    s_mul_i32 s64, s64, 229376
    buffer_load_dwordx4 v17, s[16:19], s64 offen lds
    s_add_u32 m0, s90, 106496
    s_nop 0
    buffer_load_dwordx4 v18, s[20:23], s64 offen lds
    s_waitcnt lgkmcnt(6)
    v_mfma_f32_32x32x16_bf16 v[32:47], v[120:123], v[140:143], v[32:47]
    s_waitcnt lgkmcnt(2)
    v_mfma_f32_16x16x32_bf16 v[8:11], v[240:243], v[250:253], 0
    ds_read_b64_tr_b16 v[116:117], v21 offset:16384
    ds_read_b64_tr_b16 v[118:119], v21 offset:16896
    s_lshl_b32 s67, s58, 11
    v_add_u32 v22, s67, v21
    ds_read_b64_tr_b16 v[250:251], v22 offset:0
    ds_read_b64_tr_b16 v[252:253], v22 offset:512
    s_add_u32 m0, s90, 102400
    s_add_u32 s64, s64, 114688
    buffer_load_dwordx4 v17, s[16:19], s64 offen lds
    v_mfma_f32_32x32x16_bf16 v[48:63], v[124:127], v[140:143], v[48:63]
    ds_read_b64_tr_b16 v[120:121], v20 offset:18432
    ds_read_b64_tr_b16 v[122:123], v20 offset:18944
    v_mul_f32 v24, v96, v96
    v_mul_f32 v25, v97, v97
    v_mul_f32 v26, v98, v98
    v_mul_f32 v27, v99, v99
    v_fma_f32 v24, v24, v7, v6
    v_fma_f32 v25, v25, v7, v6
    v_fma_f32 v26, v26, v7, v6
    v_fma_f32 v27, v27, v7, v6
    s_add_u32 m0, s90, 110592
    s_nop 0
    buffer_load_dwordx4 v18, s[20:23], s64 offen lds
    s_waitcnt lgkmcnt(6)
    v_mfma_f32_32x32x16_bf16 v[32:47], v[112:115], v[144:147], v[32:47]
    s_waitcnt lgkmcnt(2)
    v_mfma_f32_16x16x32_bf16 v[12:15], v[240:243], v[250:253], 0
    ds_read_b64_tr_b16 v[124:125], v21 offset:18432
    ds_read_b64_tr_b16 v[126:127], v21 offset:18944
    ds_read_b64_tr_b16 v[250:251], v16 offset:16384
    ds_read_b64_tr_b16 v[252:253], v16 offset:16896
    v_mul_f32 v24, v24, v96
    v_mul_f32 v25, v25, v97
    v_mul_f32 v26, v26, v98
    v_mul_f32 v27, v27, v99
    v_exp_f32 v24, v24
    v_exp_f32 v25, v25
    s_add_u32 m0, s90, 114688
    s_mov_b32 s64, 458752
    buffer_load_dwordx4 v19, s[24:27], s64 offen lds
    v_mfma_f32_32x32x16_bf16 v[48:63], v[116:119], v[144:147], v[48:63]
    ds_read_b64_tr_b16 v[112:113], v20 offset:20480
    ds_read_b64_tr_b16 v[114:115], v20 offset:20992
    v_exp_f32 v26, v26
    v_exp_f32 v27, v27
    v_mul_f32 v104, v96, v104
    v_mul_f32 v105, v97, v105
    v_mul_f32 v106, v98, v106
    v_mul_f32 v107, v99, v107
    s_add_u32 m0, s90, 118784
    s_mov_b32 s64, 487424
    buffer_load_dwordx4 v19, s[24:27], s64 offen lds
    s_waitcnt lgkmcnt(6)
    v_mfma_f32_32x32x16_bf16 v[32:47], v[120:123], v[148:151], v[32:47]
    s_waitcnt lgkmcnt(2)
    v_mfma_f32_16x16x32_bf16 v[8:11], v[240:243], v[250:253], v[8:11]
    ds_read_b64_tr_b16 v[116:117], v21 offset:20480
    ds_read_b64_tr_b16 v[118:119], v21 offset:20992
    ds_read_b64_tr_b16 v[250:251], v22 offset:16384
    ds_read_b64_tr_b16 v[252:253], v22 offset:16896
    v_fma_f32 v24, v24, v4, v4
    v_fma_f32 v25, v25, v4, v4
    v_fma_f32 v26, v26, v4, v4
    v_fma_f32 v27, v27, v4, v4
    v_rcp_f32 v24, v24
    v_rcp_f32 v25, v25
    s_add_u32 m0, s90, 122880
    s_mov_b32 s64, 573440
    buffer_load_dwordx4 v19, s[24:27], s64 offen lds
    v_mfma_f32_32x32x16_bf16 v[48:63], v[124:127], v[148:151], v[48:63]
    ds_read_b64_tr_b16 v[120:121], v20 offset:22528
    ds_read_b64_tr_b16 v[122:123], v20 offset:23040
    v_rcp_f32 v26, v26
    v_rcp_f32 v27, v27
    v_mul_f32 v104, v104, v24
    v_mul_f32 v105, v105, v25
    v_mul_f32 v106, v106, v26
    v_mul_f32 v107, v107, v27
    s_add_u32 m0, s90, 126976
    s_mov_b32 s64, 602112
    buffer_load_dwordx4 v19, s[24:27], s64 offen lds
    s_waitcnt lgkmcnt(6)
    v_mfma_f32_32x32x16_bf16 v[32:47], v[112:115], v[152:155], v[32:47]
    s_barrier
    s_waitcnt lgkmcnt(2)
    v_mfma_f32_16x16x32_bf16 v[12:15], v[240:243], v[250:253], v[12:15]
    ds_read_b64_tr_b16 v[124:125], v21 offset:22528
    ds_read_b64_tr_b16 v[126:127], v21 offset:23040
    v_mul_f32 v24, v100, v100
    v_mul_f32 v25, v101, v101
    v_mul_f32 v26, v102, v102
    v_mul_f32 v27, v103, v103
    v_fma_f32 v24, v24, v7, v6
    v_fma_f32 v25, v25, v7, v6
    v_fma_f32 v26, v26, v7, v6
    v_mfma_f32_32x32x16_bf16 v[48:63], v[116:119], v[152:155], v[48:63]
    ds_read_b64_tr_b16 v[112:113], v20 offset:32768
    ds_read_b64_tr_b16 v[114:115], v20 offset:33280
    ds_read_b64_tr_b16 v[250:251], v16 offset:32768
    ds_read_b64_tr_b16 v[252:253], v16 offset:33280
    v_fma_f32 v27, v27, v7, v6
    v_mul_f32 v24, v24, v100
    v_mul_f32 v25, v25, v101
    v_mul_f32 v26, v26, v102
    v_mul_f32 v27, v27, v103
    v_exp_f32 v24, v24
    v_exp_f32 v25, v25
    s_add_u32 m0, s90, 0
    s_mov_b32 s64, 688128
    buffer_load_dwordx4 v19, s[24:27], s64 offen lds
    s_waitcnt lgkmcnt(6)
    v_mfma_f32_32x32x16_bf16 v[32:47], v[120:123], v[156:159], v[32:47]
    ds_read_b64_tr_b16 v[116:117], v21 offset:32768
    ds_read_b64_tr_b16 v[118:119], v21 offset:33280
    v_exp_f32 v26, v26
    v_exp_f32 v27, v27
    v_mul_f32 v108, v100, v108
    v_mul_f32 v109, v101, v109
    v_mul_f32 v110, v102, v110
    s_add_u32 m0, s90, 4096
    s_mov_b32 s64, 716800
    buffer_load_dwordx4 v19, s[24:27], s64 offen lds
    s_waitcnt lgkmcnt(6)
    v_mfma_f32_32x32x16_bf16 v[48:63], v[124:127], v[156:159], v[48:63]
    s_waitcnt lgkmcnt(2)
    v_mfma_f32_16x16x32_bf16 v[8:11], v[240:243], v[250:253], v[8:11]
    ds_read_b64_tr_b16 v[120:121], v20 offset:34816
    ds_read_b64_tr_b16 v[122:123], v20 offset:35328
    ds_read_b64_tr_b16 v[250:251], v22 offset:32768
    ds_read_b64_tr_b16 v[252:253], v22 offset:33280
    v_mul_f32 v111, v103, v111
    v_fma_f32 v24, v24, v4, v4
    v_fma_f32 v25, v25, v4, v4
    v_fma_f32 v26, v26, v4, v4
    v_fma_f32 v27, v27, v4, v4
    v_rcp_f32 v24, v24
    v_rcp_f32 v25, v25
    v_mfma_f32_32x32x16_bf16 v[32:47], v[112:115], v[160:163], v[32:47]
    ds_read_b64_tr_b16 v[124:125], v21 offset:34816
    ds_read_b64_tr_b16 v[126:127], v21 offset:35328
    v_rcp_f32 v26, v26
    v_rcp_f32 v27, v27
    v_mul_f32 v108, v108, v24
    v_mul_f32 v109, v109, v25
    v_mul_f32 v110, v110, v26
    s_add_u32 m0, s90, 8192
    s_mov_b32 s64, 860160
    buffer_load_dwordx4 v19, s[24:27], s64 offen lds
    s_waitcnt lgkmcnt(6)
    v_mfma_f32_32x32x16_bf16 v[48:63], v[116:119], v[160:163], v[48:63]
    s_waitcnt lgkmcnt(2)
    v_mfma_f32_16x16x32_bf16 v[12:15], v[240:243], v[250:253], v[12:15]
    ds_read_b64_tr_b16 v[112:113], v20 offset:36864
    ds_read_b64_tr_b16 v[114:115], v20 offset:37376
    v_mul_f32 v111, v111, v27
    v_cvt_pk_bf16_f32 v96, v104, v105
    v_cvt_pk_bf16_f32 v97, v106, v107
    v_cvt_pk_bf16_f32 v98, v108, v109
    v_cvt_pk_bf16_f32 v99, v110, v111
    s_cmp_gt_u32 s52, 0
    s_cselect_b32 s65, 0, 4
    s_mul_i32 s66, s51, 7
    s_add_u32 s65, s65, s66
    s_lshl_b32 s65, s65, 10
    s_add_u32 s65, s65, s63
    buffer_store_dwordx4 v[96:99], v2, s[32:35], s65 offen sc1
    v_mfma_f32_32x32x16_bf16 v[32:47], v[120:123], v[164:167], v[32:47]
    ds_read_b64_tr_b16 v[116:117], v21 offset:36864
    ds_read_b64_tr_b16 v[118:119], v21 offset:37376
    ds_read_b64_tr_b16 v[100:101], v31
    ds_read_b64_tr_b16 v[102:103], v31 offset:448
    ds_read_b64_tr_b16 v[104:105], v31 offset:896
    ds_read_b64_tr_b16 v[106:107], v30 offset:1344
    v_cvt_pk_bf16_f32 v80, v80, v81
    v_cvt_pk_bf16_f32 v81, v82, v83
    v_cvt_pk_bf16_f32 v82, v84, v85
    v_cvt_pk_bf16_f32 v83, v86, v87
    s_add_u32 m0, s90, 12288
    s_mov_b32 s64, 888832
    buffer_load_dwordx4 v19, s[24:27], s64 offen lds
    s_waitcnt lgkmcnt(8)
    v_mfma_f32_32x32x16_bf16 v[48:63], v[124:127], v[164:167], v[48:63]
    ds_read_b64_tr_b16 v[120:121], v20 offset:38912
    ds_read_b64_tr_b16 v[122:123], v20 offset:39424
    v_cvt_pk_bf16_f32 v84, v88, v89
    v_cvt_pk_bf16_f32 v85, v90, v91
    v_cvt_pk_bf16_f32 v86, v92, v93
    v_cvt_pk_bf16_f32 v87, v94, v95
    v_cmp_lt_u32 vcc, 31, v1
    s_waitcnt lgkmcnt(2)
    s_nop 0
    v_cndmask_b32 v106, 0, v106, vcc
    v_cndmask_b32 v107, 0, v107, vcc
    v_mfma_f32_32x32x16_bf16 v[32:47], v[112:115], v[168:171], v[32:47]
    s_barrier
    ds_read_b64_tr_b16 v[124:125], v21 offset:38912
    ds_read_b64_tr_b16 v[126:127], v21 offset:39424
    v_mfma_f32_32x32x16_bf16 v[64:79], v[100:103], v[80:83], 0
    v_mfma_f32_32x32x16_bf16 v[64:79], v[104:107], v[84:87], v[64:79]
    v_mfma_f32_32x32x16_bf16 v[48:63], v[116:119], v[168:171], v[48:63]
    ds_read_b64_tr_b16 v[112:113], v20 offset:49152
    ds_read_b64_tr_b16 v[114:115], v20 offset:49664
    ds_read_b64_tr_b16 v[250:251], v16 offset:49152
    ds_read_b64_tr_b16 v[252:253], v16 offset:49664
    s_add_u32 m0, s90, 16384
    s_mov_b32 s64, 974848
    buffer_load_dwordx4 v19, s[24:27], s64 offen lds
    s_waitcnt lgkmcnt(6)
    v_mfma_f32_32x32x16_bf16 v[32:47], v[120:123], v[172:175], v[32:47]
    ds_read_b64_tr_b16 v[116:117], v21 offset:49152
    ds_read_b64_tr_b16 v[118:119], v21 offset:49664
    v_max3_f32 v24, v64, v65, v66
    v_max3_f32 v25, -v64, -v65, -v66
    v_max3_f32 v26, v67, v68, v69
    v_max3_f32 v27, -v67, -v68, -v69
    v_max3_f32 v24, v24, v70, v71
    v_max3_f32 v25, v25, -v70, -v71
    v_max3_f32 v26, v26, v72, v73
    v_max3_f32 v27, v27, -v72, -v73
    s_add_u32 m0, s90, 20480
    s_mov_b32 s64, 1003520
    buffer_load_dwordx4 v19, s[24:27], s64 offen lds
    s_waitcnt lgkmcnt(6)
    v_mfma_f32_32x32x16_bf16 v[48:63], v[124:127], v[172:175], v[48:63]
    s_waitcnt lgkmcnt(2)
    v_mfma_f32_16x16x32_bf16 v[8:11], v[240:243], v[250:253], v[8:11]
    ds_read_b64_tr_b16 v[120:121], v20 offset:51200
    ds_read_b64_tr_b16 v[122:123], v20 offset:51712
    ds_read_b64_tr_b16 v[250:251], v22 offset:49152
    ds_read_b64_tr_b16 v[252:253], v22 offset:49664
    v_max3_f32 v24, v24, v74, v75
    v_max3_f32 v25, v25, -v74, -v75
    v_max3_f32 v26, v26, v76, v77
    v_max3_f32 v27, v27, -v76, -v77
    v_max3_f32 v24, v24, v78, v79
    v_max3_f32 v25, v25, -v78, -v79
    v_max_f32 v24, v24, v26
    v_mfma_f32_32x32x16_bf16 v[32:47], v[112:115], v[176:179], v[32:47]
    ds_read_b64_tr_b16 v[124:125], v21 offset:51200
    ds_read_b64_tr_b16 v[126:127], v21 offset:51712
    v_max_f32 v25, v25, v27
    s_nop 1
    v_permlane32_swap_b32 v24, v25
    v_max_f32 v24, v24, v25
    v_mul_f32_e64 v24, -v5, v24
    v_mov_b32 v25, v24
    s_nop 1
    v_permlane32_swap_b32 v24, v25
    s_add_u32 m0, s90, 24576
    s_mov_b32 s64, 1089536
    buffer_load_dwordx4 v19, s[24:27], s64 offen lds
    s_waitcnt lgkmcnt(6)
    v_mfma_f32_32x32x16_bf16 v[48:63], v[116:119], v[176:179], v[48:63]
    s_waitcnt lgkmcnt(2)
    v_mfma_f32_16x16x32_bf16 v[12:15], v[240:243], v[250:253], v[12:15]
    ds_read_b64_tr_b16 v[112:113], v20 offset:53248
    ds_read_b64_tr_b16 v[114:115], v20 offset:53760
    v_fma_f32 v80, v64, v5, v24
    v_fma_f32 v64, -v64, v5, v25
    v_fma_f32 v81, v65, v5, v24
    v_fma_f32 v65, -v65, v5, v25
    v_exp_f32 v80, v80
    v_mfma_f32_32x32x16_bf16 v[32:47], v[120:123], v[180:183], v[32:47]
    ds_read_b64_tr_b16 v[116:117], v21 offset:53248
    ds_read_b64_tr_b16 v[118:119], v21 offset:53760
    v_exp_f32 v64, v64
    v_fma_f32 v82, v66, v5, v24
    v_fma_f32 v66, -v66, v5, v25
    v_exp_f32 v81, v81
    v_exp_f32 v65, v65
    s_add_u32 m0, s90, 28672
    s_mov_b32 s64, 1118208
    buffer_load_dwordx4 v19, s[24:27], s64 offen lds
    s_waitcnt lgkmcnt(4)
    v_mfma_f32_32x32x16_bf16 v[48:63], v[124:127], v[180:183], v[48:63]
    ds_read_b64_tr_b16 v[120:121], v20 offset:55296
    ds_read_b64_tr_b16 v[122:123], v20 offset:55808
    v_fma_f32 v83, v67, v5, v24
    v_fma_f32 v67, -v67, v5, v25
    v_exp_f32 v82, v82
    v_exp_f32 v66, v66
    s_waitcnt lgkmcnt(4)
    v_mfma_f32_32x32x16_bf16 v[32:47], v[112:115], v[184:187], v[32:47]
    s_waitcnt vmcnt(27)
    s_barrier
    ds_read_b64_tr_b16 v[124:125], v21 offset:55296
    ds_read_b64_tr_b16 v[126:127], v21 offset:55808
    v_fma_f32 v84, v68, v5, v24
    v_fma_f32 v68, -v68, v5, v25
    v_exp_f32 v83, v83
    v_exp_f32 v67, v67
    v_fma_f32 v85, v69, v5, v24
    s_waitcnt lgkmcnt(4)
    v_mfma_f32_32x32x16_bf16 v[48:63], v[116:119], v[184:187], v[48:63]
    v_add_u32 v20, 0x00010000, v20
    ds_read_b64_tr_b16 v[112:113], v20 offset:0
    ds_read_b64_tr_b16 v[114:115], v20 offset:512
    v_add_u32 v16, 0x00010000, v16
    ds_read_b64_tr_b16 v[250:251], v16 offset:0
    ds_read_b64_tr_b16 v[252:253], v16 offset:512
    v_fma_f32 v69, -v69, v5, v25
    v_exp_f32 v84, v84
    v_exp_f32 v68, v68
    v_fma_f32 v86, v70, v5, v24
    v_fma_f32 v70, -v70, v5, v25
    s_add_u32 m0, s90, 32768
    s_mov_b32 s64, 1261568
    buffer_load_dwordx4 v19, s[24:27], s64 offen lds
    s_waitcnt lgkmcnt(6)
    v_mfma_f32_32x32x16_bf16 v[32:47], v[120:123], v[188:191], v[32:47]
    v_add_u32 v21, 0x00010000, v21
    ds_read_b64_tr_b16 v[116:117], v21 offset:0
    ds_read_b64_tr_b16 v[118:119], v21 offset:512
    v_exp_f32 v85, v85
    v_exp_f32 v69, v69
    v_fma_f32 v87, v71, v5, v24
    v_fma_f32 v71, -v71, v5, v25
    v_exp_f32 v86, v86
    s_waitcnt vmcnt(6)
    v_mov_b32 v28, s56
    v_mov_b32 v29, s57
    s_mov_b64 exec, 1
    buffer_store_dwordx2 v[28:29], off, s[32:35], s78 offset:0 sc1
    s_mov_b64 exec, -1
    s_add_u32 m0, s90, 36864
    s_mov_b32 s64, 1290240
    buffer_load_dwordx4 v19, s[24:27], s64 offen lds
    s_waitcnt lgkmcnt(6)
    v_mfma_f32_32x32x16_bf16 v[48:63], v[124:127], v[188:191], v[48:63]
    s_waitcnt lgkmcnt(2)
    v_mfma_f32_16x16x32_bf16 v[8:11], v[240:243], v[250:253], v[8:11]
    ds_read_b64_tr_b16 v[120:121], v20 offset:2048
    ds_read_b64_tr_b16 v[122:123], v20 offset:2560
    v_add_u32 v22, 0x00010000, v22
    ds_read_b64_tr_b16 v[250:251], v22 offset:0
    ds_read_b64_tr_b16 v[252:253], v22 offset:512
    v_exp_f32 v70, v70
    v_fma_f32 v88, v72, v5, v24
    v_fma_f32 v72, -v72, v5, v25
    v_exp_f32 v87, v87
    v_mfma_f32_32x32x16_bf16 v[32:47], v[112:115], v[192:195], v[32:47]
    ds_read_b64_tr_b16 v[124:125], v21 offset:2048
    ds_read_b64_tr_b16 v[126:127], v21 offset:2560
    v_exp_f32 v71, v71
    v_fma_f32 v89, v73, v5, v24
    v_fma_f32 v73, -v73, v5, v25
    v_exp_f32 v88, v88
    v_exp_f32 v72, v72
    s_add_u32 m0, s90, 40960
    s_mov_b32 s64, 1376256
    buffer_load_dwordx4 v19, s[24:27], s64 offen lds
    s_waitcnt lgkmcnt(6)
    v_mfma_f32_32x32x16_bf16 v[48:63], v[116:119], v[192:195], v[48:63]
    s_waitcnt lgkmcnt(2)
    v_mfma_f32_16x16x32_bf16 v[12:15], v[240:243], v[250:253], v[12:15]
    ds_read_b64_tr_b16 v[112:113], v20 offset:4096
    ds_read_b64_tr_b16 v[114:115], v20 offset:4608
    v_fma_f32 v90, v74, v5, v24
    v_fma_f32 v74, -v74, v5, v25
    v_exp_f32 v89, v89
    v_exp_f32 v73, v73
    v_mfma_f32_32x32x16_bf16 v[32:47], v[120:123], v[196:199], v[32:47]
    ds_read_b64_tr_b16 v[116:117], v21 offset:4096
    ds_read_b64_tr_b16 v[118:119], v21 offset:4608
    v_fma_f32 v91, v75, v5, v24
    v_fma_f32 v75, -v75, v5, v25
    v_exp_f32 v90, v90
    v_exp_f32 v74, v74
    v_fma_f32 v92, v76, v5, v24
    s_add_u32 m0, s90, 45056
    s_mov_b32 s64, 1404928
    buffer_load_dwordx4 v19, s[24:27], s64 offen lds
    s_waitcnt lgkmcnt(4)
    v_mfma_f32_32x32x16_bf16 v[48:63], v[124:127], v[196:199], v[48:63]
    ds_read_b64_tr_b16 v[120:121], v20 offset:6144
    ds_read_b64_tr_b16 v[122:123], v20 offset:6656
    v_fma_f32 v76, -v76, v5, v25
    v_exp_f32 v91, v91
    v_exp_f32 v75, v75
    v_fma_f32 v93, v77, v5, v24
    v_fma_f32 v77, -v77, v5, v25
    s_waitcnt lgkmcnt(4)
    v_mfma_f32_32x32x16_bf16 v[32:47], v[112:115], v[200:203], v[32:47]
    s_barrier
    ds_read_b64_tr_b16 v[124:125], v21 offset:6144
    ds_read_b64_tr_b16 v[126:127], v21 offset:6656
    v_exp_f32 v92, v92
    v_exp_f32 v76, v76
    v_fma_f32 v94, v78, v5, v24
    v_fma_f32 v78, -v78, v5, v25
    v_exp_f32 v93, v93
    s_waitcnt lgkmcnt(4)
    v_mfma_f32_32x32x16_bf16 v[48:63], v[116:119], v[200:203], v[48:63]
    ds_read_b64_tr_b16 v[112:113], v20 offset:16384
    ds_read_b64_tr_b16 v[114:115], v20 offset:16896
    ds_read_b64_tr_b16 v[250:251], v16 offset:16384
    ds_read_b64_tr_b16 v[252:253], v16 offset:16896
    v_exp_f32 v77, v77
    v_fma_f32 v95, v79, v5, v24
    v_fma_f32 v79, -v79, v5, v25
    v_exp_f32 v94, v94
    s_add_u32 m0, s90, 49152
    s_mov_b32 s64, 1490944
    buffer_load_dwordx4 v19, s[24:27], s64 offen lds
    s_waitcnt lgkmcnt(6)
    v_mfma_f32_32x32x16_bf16 v[32:47], v[120:123], v[204:207], v[32:47]
    ds_read_b64_tr_b16 v[116:117], v21 offset:16384
    ds_read_b64_tr_b16 v[118:119], v21 offset:16896
    v_exp_f32 v78, v78
    v_exp_f32 v95, v95
    v_exp_f32 v79, v79
    v_add_f32 v24, v80, v81
    v_add_f32 v25, v64, v65
    s_add_u32 m0, s90, 53248
    s_mov_b32 s64, 1519616
    buffer_load_dwordx4 v19, s[24:27], s64 offen lds
    s_waitcnt lgkmcnt(6)
    v_mfma_f32_32x32x16_bf16 v[48:63], v[124:127], v[204:207], v[48:63]
    s_waitcnt lgkmcnt(2)
    v_mfma_f32_16x16x32_bf16 v[8:11], v[240:243], v[250:253], v[8:11]
    ds_read_b64_tr_b16 v[120:121], v20 offset:18432
    ds_read_b64_tr_b16 v[122:123], v20 offset:18944
    ds_read_b64_tr_b16 v[250:251], v22 offset:16384
    ds_read_b64_tr_b16 v[252:253], v22 offset:16896
    v_add_f32 v26, v92, v93
    v_add_f32 v27, v76, v77
    v_add_f32 v24, v24, v82
    v_add_f32 v25, v25, v66
    v_add_f32 v26, v26, v94
    v_add_f32 v27, v27, v78
    v_add_f32 v24, v24, v83
    v_mfma_f32_32x32x16_bf16 v[32:47], v[112:115], v[208:211], v[32:47]
    ds_read_b64_tr_b16 v[124:125], v21 offset:18432
    ds_read_b64_tr_b16 v[126:127], v21 offset:18944
    v_add_f32 v25, v25, v67
    v_add_f32 v26, v26, v95
    v_add_f32 v27, v27, v79
    v_add_f32 v24, v24, v84
    v_add_f32 v25, v25, v68
    v_add_f32 v24, v24, v85
    v_add_f32 v25, v25, v69
    s_add_u32 m0, s90, 57344
    s_mov_b32 s64, 0
    buffer_load_dwordx4 v19, s[24:27], s64 offen lds
    s_waitcnt lgkmcnt(6)
    v_mfma_f32_32x32x16_bf16 v[48:63], v[116:119], v[208:211], v[48:63]
    s_waitcnt lgkmcnt(2)
    v_mfma_f32_16x16x32_bf16 v[12:15], v[240:243], v[250:253], v[12:15]
    ds_read_b64_tr_b16 v[112:113], v20 offset:20480
    ds_read_b64_tr_b16 v[114:115], v20 offset:20992
    v_add_f32 v24, v24, v86
    v_add_f32 v25, v25, v70
    v_add_f32 v24, v24, v87
    v_add_f32 v25, v25, v71
    v_add_f32 v24, v24, v88
    v_add_f32 v25, v25, v72
    v_add_f32 v24, v24, v89
    v_mfma_f32_32x32x16_bf16 v[32:47], v[120:123], v[212:215], v[32:47]
    ds_read_b64_tr_b16 v[116:117], v21 offset:20480
    ds_read_b64_tr_b16 v[118:119], v21 offset:20992
    v_add_f32 v25, v25, v73
    v_add_f32 v24, v24, v90
    v_add_f32 v25, v25, v74
    v_add_f32 v24, v24, v91
    v_add_f32 v25, v25, v75
    v_fmac_f32 v24, v26, v3
    v_fmac_f32 v25, v27, v3
    s_add_u32 m0, s90, 61440
    s_mov_b32 s64, 28672
    buffer_load_dwordx4 v19, s[24:27], s64 offen lds
    s_waitcnt lgkmcnt(4)
    v_mfma_f32_32x32x16_bf16 v[48:63], v[124:127], v[212:215], v[48:63]
    ds_read_b64_tr_b16 v[120:121], v20 offset:22528
    ds_read_b64_tr_b16 v[122:123], v20 offset:23040
    v_permlane32_swap_b32 v24, v25
    v_add_f32 v24, v24, v25
    v_rcp_f32 v24, v24
    s_nop 0
    v_mov_b32 v25, v24
    s_nop 1
    v_permlane32_swap_b32 v24, v25
    s_waitcnt lgkmcnt(4)
    v_mfma_f32_32x32x16_bf16 v[32:47], v[112:115], v[216:219], v[32:47]
    s_barrier
    ds_read_b64_tr_b16 v[124:125], v21 offset:22528
    ds_read_b64_tr_b16 v[126:127], v21 offset:23040
    v_mul_f32 v26, v24, v3
    v_mul_f32 v27, v25, v3
    v_mul_f32 v80, v80, v24
    v_mul_f32 v81, v81, v24
    v_mul_f32 v64, v64, v25
    v_mul_f32 v65, v65, v25
    s_waitcnt lgkmcnt(4)
    v_mfma_f32_32x32x16_bf16 v[48:63], v[116:119], v[216:219], v[48:63]
    ds_read_b64_tr_b16 v[112:113], v20 offset:32768
    ds_read_b64_tr_b16 v[114:115], v20 offset:33280
    ds_read_b64_tr_b16 v[250:251], v16 offset:32768
    ds_read_b64_tr_b16 v[252:253], v16 offset:33280
    v_cvt_pk_bf16_f32 v80, v80, v81
    v_cvt_pk_bf16_f32 v64, v64, v65
    v_mul_f32 v82, v82, v24
    v_mul_f32 v83, v83, v24
    v_mul_f32 v66, v66, v25
    v_mul_f32 v67, v67, v25
    v_cvt_pk_bf16_f32 v81, v82, v83
    s_add_u32 m0, s90, 65536
    s_mov_b32 s64, 114688
    buffer_load_dwordx4 v19, s[24:27], s64 offen lds
    s_waitcnt lgkmcnt(6)
    v_mfma_f32_32x32x16_bf16 v[32:47], v[120:123], v[220:223], v[32:47]
    ds_read_b64_tr_b16 v[116:117], v21 offset:32768
    ds_read_b64_tr_b16 v[118:119], v21 offset:33280
    v_cvt_pk_bf16_f32 v65, v66, v67
    v_mul_f32 v84, v84, v24
    v_mul_f32 v85, v85, v24
    v_mul_f32 v68, v68, v25
    v_mul_f32 v69, v69, v25
    v_cvt_pk_bf16_f32 v82, v84, v85
    v_cvt_pk_bf16_f32 v66, v68, v69
    s_add_u32 m0, s90, 69632
    s_mov_b32 s64, 143360
    buffer_load_dwordx4 v19, s[24:27], s64 offen lds
    s_waitcnt lgkmcnt(6)
    v_mfma_f32_32x32x16_bf16 v[48:63], v[124:127], v[220:223], v[48:63]
    s_waitcnt lgkmcnt(2)
    v_mfma_f32_16x16x32_bf16 v[8:11], v[240:243], v[250:253], v[8:11]
    ds_read_b64_tr_b16 v[120:121], v20 offset:34816
    ds_read_b64_tr_b16 v[122:123], v20 offset:35328
    ds_read_b64_tr_b16 v[250:251], v22 offset:32768
    ds_read_b64_tr_b16 v[252:253], v22 offset:33280
    v_mul_f32 v86, v86, v24
    v_mul_f32 v87, v87, v24
    v_mul_f32 v70, v70, v25
    v_mul_f32 v71, v71, v25
    v_cvt_pk_bf16_f32 v83, v86, v87
    v_cvt_pk_bf16_f32 v67, v70, v71
    v_mul_f32 v88, v88, v24
    v_mfma_f32_32x32x16_bf16 v[32:47], v[112:115], v[224:227], v[32:47]
    ds_read_b64_tr_b16 v[124:125], v21 offset:34816
    ds_read_b64_tr_b16 v[126:127], v21 offset:35328
    v_mul_f32 v89, v89, v24
    v_mul_f32 v72, v72, v25
    v_mul_f32 v73, v73, v25
    v_cvt_pk_bf16_f32 v84, v88, v89
    v_cvt_pk_bf16_f32 v68, v72, v73
    v_mul_f32 v90, v90, v24
    v_mul_f32 v91, v91, v24
    s_add_u32 m0, s90, 73728
    s_mov_b32 s64, 229376
    buffer_load_dwordx4 v19, s[24:27], s64 offen lds
    s_waitcnt lgkmcnt(6)
    v_mfma_f32_32x32x16_bf16 v[48:63], v[116:119], v[224:227], v[48:63]
    s_waitcnt lgkmcnt(2)
    v_mfma_f32_16x16x32_bf16 v[12:15], v[240:243], v[250:253], v[12:15]
    ds_read_b64_tr_b16 v[112:113], v20 offset:36864
    ds_read_b64_tr_b16 v[114:115], v20 offset:37376
    v_mul_f32 v74, v74, v25
    v_mul_f32 v75, v75, v25
    v_cvt_pk_bf16_f32 v85, v90, v91
    v_cvt_pk_bf16_f32 v69, v74, v75
    v_mul_f32 v92, v92, v26
    v_mul_f32 v93, v93, v26
    v_mul_f32 v76, v76, v27
    v_mfma_f32_32x32x16_bf16 v[32:47], v[120:123], v[228:231], v[32:47]
    ds_read_b64_tr_b16 v[116:117], v21 offset:36864
    ds_read_b64_tr_b16 v[118:119], v21 offset:37376
    v_mul_f32 v77, v77, v27
    v_cvt_pk_bf16_f32 v86, v92, v93
    v_cvt_pk_bf16_f32 v70, v76, v77
    v_mul_f32 v94, v94, v26
    v_mul_f32 v95, v95, v26
    v_mul_f32 v78, v78, v27
    v_mul_f32 v79, v79, v27
    s_add_u32 m0, s90, 77824
    s_mov_b32 s64, 258048
    buffer_load_dwordx4 v19, s[24:27], s64 offen lds
    s_waitcnt lgkmcnt(4)
    v_mfma_f32_32x32x16_bf16 v[48:63], v[124:127], v[228:231], v[48:63]
    ds_read_b64_tr_b16 v[120:121], v20 offset:38912
    ds_read_b64_tr_b16 v[122:123], v20 offset:39424
    ds_write_b32 v254, v8 offset:0
    ds_write_b32 v254, v12 offset:512
    v_cvt_pk_bf16_f32 v87, v94, v95
    v_cvt_pk_bf16_f32 v71, v78, v79
    s_waitcnt lgkmcnt(6)
    v_mfma_f32_32x32x16_bf16 v[32:47], v[112:115], v[232:235], v[32:47]
    ds_read_b64_tr_b16 v[124:125], v21 offset:38912
    ds_read_b64_tr_b16 v[126:127], v21 offset:39424
    s_waitcnt lgkmcnt(2)
    s_barrier
    v_and_b32 v23, 15, v1
    v_lshlrev_b32 v23, 3, v23
    v_and_b32 v22, 31, v1
    v_lshlrev_b32 v22, 3, v22
    buffer_load_dwordx2 v[26:27], v22, s[32:35], s74 offen sc1
    v_mfma_f32_32x32x16_bf16 v[48:63], v[116:119], v[232:235], v[48:63]
    s_add_u32 m0, s90, 81920
    s_mov_b32 s64, 344064
    buffer_load_dwordx4 v19, s[24:27], s64 offen lds
    s_add_u32 m0, s90, 86016
    s_mov_b32 s64, 372736
    buffer_load_dwordx4 v19, s[24:27], s64 offen lds
    ds_read_b128 v[250:253], v255 offset:0
    v_mfma_f32_32x32x16_bf16 v[32:47], v[120:123], v[236:239], v[32:47]
    s_add_u32 m0, s90, 90112
    s_mov_b32 s64, 401408
    buffer_load_dwordx4 v19, s[24:27], s64 offen lds
    s_waitcnt lgkmcnt(1)
    v_mfma_f32_32x32x16_bf16 v[48:63], v[124:127], v[236:239], v[48:63]
    s_add_u32 m0, s90, 94208
    s_mov_b32 s64, 430080
    buffer_load_dwordx4 v19, s[24:27], s64 offen lds
    s_waitcnt lgkmcnt(0)
    v_add_f32 v250, v250, v251
    v_add_f32 v252, v252, v253
    v_add_f32 v250, v250, v252
    v_and_b32 v251, 0xffff0000, v250
    v_sub_f32 v251, v250, v251
    v_and_b32 v252, 0xffff0000, v251
    v_perm_b32 v244, v251, v250, s83
    v_sub_f32 v252, v251, v252
    v_lshrrev_b32 v245, 16, v252
    s_nop 1
    v_mfma_f32_32x32x16_bf16 v[32:47], v[244:247], v[246:249], v[32:47]
    ds_read_b128 v[250:253], v255 offset:512
    s_waitcnt lgkmcnt(0)
    v_add_f32 v250, v250, v251
    v_add_f32 v252, v252, v253
    v_add_f32 v250, v250, v252
    v_and_b32 v251, 0xffff0000, v250
    v_sub_f32 v251, v250, v251
    v_and_b32 v252, 0xffff0000, v251
    v_perm_b32 v244, v251, v250, s83
    v_sub_f32 v252, v251, v252
    v_lshrrev_b32 v245, 16, v252
    s_nop 1
    v_mfma_f32_32x32x16_bf16 v[48:63], v[244:247], v[246:249], v[48:63]
    v_pk_mul_f32 v[112:113], v[32:33], v[32:33]
    v_pk_mul_f32 v[114:115], v[34:35], v[34:35]
    v_pk_mul_f32 v[116:117], v[36:37], v[36:37]
    v_pk_mul_f32 v[118:119], v[38:39], v[38:39]
    v_pk_fma_f32 v[112:113], v[112:113], v[6:7], v[6:7] op_sel:[0,1,0] op_sel_hi:[1,1,0]
    v_pk_fma_f32 v[114:115], v[114:115], v[6:7], v[6:7] op_sel:[0,1,0] op_sel_hi:[1,1,0]
    v_pk_fma_f32 v[116:117], v[116:117], v[6:7], v[6:7] op_sel:[0,1,0] op_sel_hi:[1,1,0]
    v_pk_fma_f32 v[118:119], v[118:119], v[6:7], v[6:7] op_sel:[0,1,0] op_sel_hi:[1,1,0]
    v_pk_mul_f32 v[112:113], v[112:113], v[32:33]
    v_pk_mul_f32 v[114:115], v[114:115], v[34:35]
    v_pk_mul_f32 v[116:117], v[116:117], v[36:37]
    v_pk_mul_f32 v[118:119], v[118:119], v[38:39]
    v_exp_f32 v112, v112
    v_exp_f32 v113, v113
    v_exp_f32 v114, v114
    v_exp_f32 v115, v115
    v_exp_f32 v116, v116
    v_exp_f32 v117, v117
    v_exp_f32 v118, v118
    v_exp_f32 v119, v119
    v_pk_mul_f32 v[40:41], v[32:33], v[40:41]
    v_pk_mul_f32 v[42:43], v[34:35], v[42:43]
    v_pk_mul_f32 v[44:45], v[36:37], v[44:45]
    v_pk_mul_f32 v[46:47], v[38:39], v[46:47]
    v_pk_fma_f32 v[112:113], v[112:113], v[4:5], v[4:5] op_sel_hi:[1,0,0]
    v_pk_fma_f32 v[114:115], v[114:115], v[4:5], v[4:5] op_sel_hi:[1,0,0]
    v_pk_fma_f32 v[116:117], v[116:117], v[4:5], v[4:5] op_sel_hi:[1,0,0]
    v_pk_fma_f32 v[118:119], v[118:119], v[4:5], v[4:5] op_sel_hi:[1,0,0]
    v_rcp_f32 v112, v112
    v_rcp_f32 v113, v113
    v_rcp_f32 v114, v114
    v_rcp_f32 v115, v115
    v_rcp_f32 v116, v116
    v_rcp_f32 v117, v117
    v_rcp_f32 v118, v118
    v_rcp_f32 v119, v119
    v_pk_mul_f32 v[40:41], v[40:41], v[112:113]
    v_pk_mul_f32 v[42:43], v[42:43], v[114:115]
    v_pk_mul_f32 v[44:45], v[44:45], v[116:117]
    v_pk_mul_f32 v[46:47], v[46:47], v[118:119]
    v_cvt_pk_bf16_f32 v32, v40, v41
    v_cvt_pk_bf16_f32 v33, v42, v43
    v_cvt_pk_bf16_f32 v34, v44, v45
    v_cvt_pk_bf16_f32 v35, v46, v47
    s_mul_i32 s65, s51, 7
    s_add_u32 s65, s65, s52
    s_add_u32 s65, s65, 0
    s_lshl_b32 s65, s65, 10
    s_add_u32 s65, s65, s63
    buffer_store_dwordx4 v[32:35], v2, s[32:35], s65 offen sc1
    v_pk_mul_f32 v[112:113], v[48:49], v[48:49]
    v_pk_mul_f32 v[114:115], v[50:51], v[50:51]
    v_pk_mul_f32 v[116:117], v[52:53], v[52:53]
    v_pk_mul_f32 v[118:119], v[54:55], v[54:55]
    v_pk_fma_f32 v[112:113], v[112:113], v[6:7], v[6:7] op_sel:[0,1,0] op_sel_hi:[1,1,0]
    v_pk_fma_f32 v[114:115], v[114:115], v[6:7], v[6:7] op_sel:[0,1,0] op_sel_hi:[1,1,0]
    v_pk_fma_f32 v[116:117], v[116:117], v[6:7], v[6:7] op_sel:[0,1,0] op_sel_hi:[1,1,0]
    v_pk_fma_f32 v[118:119], v[118:119], v[6:7], v[6:7] op_sel:[0,1,0] op_sel_hi:[1,1,0]
    v_pk_mul_f32 v[112:113], v[112:113], v[48:49]
    v_pk_mul_f32 v[114:115], v[114:115], v[50:51]
    v_pk_mul_f32 v[116:117], v[116:117], v[52:53]
    v_pk_mul_f32 v[118:119], v[118:119], v[54:55]
    v_exp_f32 v112, v112
    v_exp_f32 v113, v113
    v_exp_f32 v114, v114
    v_exp_f32 v115, v115
    v_exp_f32 v116, v116
    v_exp_f32 v117, v117
    v_exp_f32 v118, v118
    v_exp_f32 v119, v119
    v_pk_mul_f32 v[56:57], v[48:49], v[56:57]
    v_pk_mul_f32 v[58:59], v[50:51], v[58:59]
    v_pk_mul_f32 v[60:61], v[52:53], v[60:61]
    v_pk_mul_f32 v[62:63], v[54:55], v[62:63]
    v_pk_fma_f32 v[112:113], v[112:113], v[4:5], v[4:5] op_sel_hi:[1,0,0]
    v_pk_fma_f32 v[114:115], v[114:115], v[4:5], v[4:5] op_sel_hi:[1,0,0]
    v_pk_fma_f32 v[116:117], v[116:117], v[4:5], v[4:5] op_sel_hi:[1,0,0]
    v_pk_fma_f32 v[118:119], v[118:119], v[4:5], v[4:5] op_sel_hi:[1,0,0]
    v_rcp_f32 v112, v112
    v_rcp_f32 v113, v113
    v_rcp_f32 v114, v114
    v_rcp_f32 v115, v115
    v_rcp_f32 v116, v116
    v_rcp_f32 v117, v117
    v_rcp_f32 v118, v118
    v_rcp_f32 v119, v119
    v_pk_mul_f32 v[56:57], v[56:57], v[112:113]
    v_pk_mul_f32 v[58:59], v[58:59], v[114:115]
    v_pk_mul_f32 v[60:61], v[60:61], v[116:117]
    v_pk_mul_f32 v[62:63], v[62:63], v[118:119]
    v_cvt_pk_bf16_f32 v48, v56, v57
    v_cvt_pk_bf16_f32 v49, v58, v59
    v_cvt_pk_bf16_f32 v50, v60, v61
    v_cvt_pk_bf16_f32 v51, v62, v63
    s_mul_i32 s65, s51, 7
    s_add_u32 s65, s65, s52
    s_add_u32 s65, s65, 1
    s_lshl_b32 s65, s65, 10
    s_add_u32 s65, s65, s63
    buffer_store_dwordx4 v[48:51], v2, s[32:35], s65 offen sc1
    s_waitcnt vmcnt(6)
    v_cmp_ne_u64 vcc, s[56:57], v[26:27]
    s_cbranch_vccnz L_slow_R0
L_res_R0:
    s_cmp_ge_u32 s61, 28
    s_cbranch_scc1 L_exit0
    s_add_u32 s65, s73, 4096
    buffer_load_dwordx4 v[128:131], v2, s[32:35], s65 offen sc1
    v_bfe_u32 v24, v1, 2, 2
    v_bfe_u32 v26, v1, 4, 1
    v_and_b32 v27, 2, v24
    s_add_u32 s65, s73, 12288
    buffer_load_dwordx4 v[132:135], v2, s[32:35], s65 offen sc1
    v_xor_b32 v26, v26, v27
    v_and_b32 v27, 3, v1
    s_add_u32 s65, s73, 20480
    buffer_load_dwordx4 v[136:139], v2, s[32:35], s65 offen sc1
    v_lshlrev_b32 v27, 3, v27
    v_lshl_add_u32 v27, v24, 7, v27
    s_add_u32 s65, s73, 32768
    buffer_load_dwordx4 v[140:143], v2, s[32:35], s65 offen sc1
    v_lshl_add_u32 v27, v26, 5, v27
    v_lshrrev_b32 v25, 5, v1
    s_add_u32 s65, s73, 40960
    buffer_load_dwordx4 v[144:147], v2, s[32:35], s65 offen sc1
    v_lshl_add_u32 v26, v25, 9, v27
    s_lshl_b32 s66, s58, 11
    s_add_u32 s65, s73, 49152
    buffer_load_dwordx4 v[148:151], v2, s[32:35], s65 offen sc1
    v_add_u32 v8, s66, v26
    v_xor_b32 v11, 64, v8
    s_add_u32 s65, s73, 61440
    buffer_load_dwordx4 v[152:155], v2, s[32:35], s65 offen sc1
    v_add_u32 v9, 0x10000, v8
    v_add_u32 v10, 0x20000, v8
    s_add_u32 s65, s73, 69632
    buffer_load_dwordx4 v[156:159], v2, s[32:35], s65 offen sc1
    v_add_u32 v12, 0x10000, v11
    v_add_u32 v13, 0x20000, v11
    s_barrier
    ds_read_b64_tr_b16 v[240:241], v10 offset:0
    ds_read_b64_tr_b16 v[242:243], v10 offset:1024
    ds_read_b64_tr_b16 v[244:245], v13 offset:0
    ds_read_b64_tr_b16 v[246:247], v13 offset:1024
    ds_read_b64_tr_b16 v[248:249], v10 offset:8192
    ds_read_b64_tr_b16 v[250:251], v10 offset:9216
    s_waitcnt vmcnt(7) lgkmcnt(4)
    v_mfma_f32_32x32x16_bf16 v[96:111], v[240:243], v[128:131], 0
    ds_read_b64_tr_b16 v[252:253], v13 offset:8192
    ds_read_b64_tr_b16 v[254:255], v13 offset:9216
    s_add_u32 s65, s73, 77824
    buffer_load_dwordx4 v[160:163], v2, s[32:35], s65 offen sc1
    s_lshr_b32 s66, s58, 1
    s_mul_i32 s66, s66, 3584
    s_and_b32 s67, s58, 1
    s_cmp_eq_u32 s67, 0
    s_cselect_b64 vcc, -1, 0
    v_cndmask_b32 v27, v27, v26, vcc
    s_lshl_b32 s67, s67, 11
    s_add_u32 s66, s66, s67
    s_add_u32 s66, s66, 32768
    v_add_u32 v14, s66, v26
    s_add_u32 s66, s66, 1024
    v_add_u32 v15, s66, v27
    v_xor_b32 v16, 64, v14
    v_xor_b32 v17, 64, v15
    v_and_b32 v24, 31, v1
    s_lshl_b32 s66, s76, 5
    v_add_u32 v24, s66, v24
    v_mul_u32_u24 v24, 896, v24
    v_lshl_add_u32 v24, v25, 4, v24
    s_lshl_b32 s66, s75, 7
    s_lshl_b32 s67, s58, 5
    s_add_u32 s66, s66, s67
    v_add_u32 v18, s66, v24
    s_add_u32 s69, s74, 512
    s_waitcnt lgkmcnt(4)
    v_mfma_f32_32x32x16_bf16 v[112:127], v[244:247], v[128:131], 0
    ds_read_b64_tr_b16 v[240:241], v10 offset:16384
    ds_read_b64_tr_b16 v[242:243], v10 offset:17408
    s_add_u32 s65, s73, 90112
    buffer_load_dwordx4 v[164:167], v2, s[32:35], s65 offen sc1
    v_add_u32 v40, 159744, v2
    ds_read_b128 v[72:75], v40 offset:0
    ds_read_b128 v[76:79], v40 offset:1024
    ds_read_b128 v[88:91], v40 offset:2048
    ds_read_b128 v[92:95], v40 offset:3072
    s_waitcnt vmcnt(8) lgkmcnt(8)
    v_mfma_f32_32x32x16_bf16 v[96:111], v[248:251], v[132:135], v[96:111]
    ds_read_b64_tr_b16 v[244:245], v13 offset:16384
    ds_read_b64_tr_b16 v[246:247], v13 offset:17408
    s_add_u32 s65, s73, 98304
    buffer_load_dwordx4 v[168:171], v2, s[32:35], s65 offen sc1
    s_waitcnt lgkmcnt(8)
    v_mfma_f32_32x32x16_bf16 v[112:127], v[252:255], v[132:135], v[112:127]
    ds_read_b64_tr_b16 v[248:249], v9 offset:49152
    ds_read_b64_tr_b16 v[250:251], v9 offset:50176
    s_add_u32 s65, s73, 106496
    buffer_load_dwordx4 v[172:175], v2, s[32:35], s65 offen sc1
    s_waitcnt lgkmcnt(7)
    v_mfma_f32_32x32x16_bf16 v[48:63], v[72:75], v[80:83], 0
    s_waitcnt lgkmcnt(6)
    v_mfma_f32_32x32x16_bf16 v[48:63], v[76:79], v[84:87], v[48:63]
    s_waitcnt lgkmcnt(5)
    v_mfma_f32_32x32x16_bf16 v[48:63], v[88:91], v[64:67], v[48:63]
    s_waitcnt lgkmcnt(4)
    v_mfma_f32_32x32x16_bf16 v[48:63], v[92:95], v[68:71], v[48:63]
    s_waitcnt vmcnt(9)
    v_mfma_f32_32x32x16_bf16 v[96:111], v[240:243], v[136:139], v[96:111]
    s_barrier
    ds_read_b64_tr_b16 v[252:253], v12 offset:49152
    ds_read_b64_tr_b16 v[254:255], v12 offset:50176
    s_add_u32 m0, s90, 98304
    s_mov_b32 s64, 516096
    buffer_load_dwordx4 v19, s[24:27], s64 offen lds
    v_mov_b32 v28, s56
    v_mov_b32 v29, s57
    s_mov_b64 exec, 1
    buffer_store_dwordx2 v[28:29], off, s[32:35], s78 offset:256 sc1
    s_mov_b64 exec, -1
    s_waitcnt lgkmcnt(4)
    v_mfma_f32_32x32x16_bf16 v[112:127], v[244:247], v[136:139], v[112:127]
    ds_read_b64_tr_b16 v[240:241], v9 offset:57344
    ds_read_b64_tr_b16 v[242:243], v9 offset:58368
    s_add_u32 m0, s90, 106496
    s_mov_b32 s64, 630784
    buffer_load_dwordx4 v19, s[24:27], s64 offen lds
    s_waitcnt vmcnt(11) lgkmcnt(4)
    v_mfma_f32_32x32x16_bf16 v[96:111], v[248:251], v[140:143], v[96:111]
    ds_read_b64_tr_b16 v[244:245], v12 offset:57344
    ds_read_b64_tr_b16 v[246:247], v12 offset:58368
    v_add_f32 v40, 0x358637bd, v60
    v_rcp_f32 v40, v40
    s_nop 0
    v_mov_b32 v41, v40
    s_nop 1
    v_permlane32_swap_b32 v40, v41
    v_mul_f32 v41, v40, v3
    v_mul_f32 v48, v48, v40
    v_mul_f32 v49, v49, v40
    s_waitcnt lgkmcnt(4)
    v_mfma_f32_32x32x16_bf16 v[112:127], v[252:255], v[140:143], v[112:127]
    ds_read_b64_tr_b16 v[248:249], v8 offset:0
    ds_read_b64_tr_b16 v[250:251], v8 offset:1024
    v_mul_f32 v50, v50, v40
    v_mul_f32 v51, v51, v40
    v_mul_f32 v52, v52, v40
    v_mul_f32 v53, v53, v40
    v_mul_f32 v54, v54, v40
    v_mul_f32 v55, v55, v40
    v_mul_f32 v56, v56, v40
    v_mul_f32 v57, v57, v40
    s_waitcnt vmcnt(10) lgkmcnt(4)
    v_mfma_f32_32x32x16_bf16 v[96:111], v[240:243], v[144:147], v[96:111]
    ds_read_b64_tr_b16 v[252:253], v11 offset:0
    ds_read_b64_tr_b16 v[254:255], v11 offset:1024
    v_mul_f32 v58, v58, v40
    v_mul_f32 v59, v59, v40
    v_mul_f32 v60, v60, v41
    v_mul_f32 v61, v61, v41
    v_mul_f32 v62, v62, v41
    v_mul_f32 v63, v63, v41
    v_cvt_pk_bf16_f32 v72, v48, v49
    v_cvt_pk_bf16_f32 v73, v50, v51
    s_waitcnt lgkmcnt(4)
    v_mfma_f32_32x32x16_bf16 v[112:127], v[244:247], v[144:147], v[112:127]
    ds_read_b64_tr_b16 v[240:241], v8 offset:8192
    ds_read_b64_tr_b16 v[242:243], v8 offset:9216
    v_cvt_pk_bf16_f32 v74, v52, v53
    v_cvt_pk_bf16_f32 v75, v54, v55
    v_cvt_pk_bf16_f32 v76, v56, v57
    v_cvt_pk_bf16_f32 v77, v58, v59
    v_cvt_pk_bf16_f32 v78, v60, v61
    v_cvt_pk_bf16_f32 v79, v62, v63
    s_lshl_b32 s65, s50, 1
    s_add_u32 s65, s65, 112
    s_lshl_b32 s65, s65, 10
    s_add_u32 s65, s65, s63
    buffer_store_dwordx4 v[72:75], v2, s[32:35], s65 offen sc1
    buffer_store_dwordx4 v[76:79], v2, s[32:35], s65 offen offset:1024 sc1
    s_waitcnt vmcnt(11) lgkmcnt(4)
    v_mfma_f32_32x32x16_bf16 v[96:111], v[248:251], v[148:151], v[96:111]
    ds_read_b64_tr_b16 v[244:245], v11 offset:8192
    ds_read_b64_tr_b16 v[246:247], v11 offset:9216
    s_waitcnt lgkmcnt(4)
    v_mfma_f32_32x32x16_bf16 v[112:127], v[252:255], v[148:151], v[112:127]
    ds_read_b64_tr_b16 v[248:249], v8 offset:16384
    ds_read_b64_tr_b16 v[250:251], v8 offset:17408
    s_waitcnt vmcnt(10) lgkmcnt(4)
    v_mfma_f32_32x32x16_bf16 v[96:111], v[240:243], v[152:155], v[96:111]
    s_barrier
    ds_read_b64_tr_b16 v[252:253], v11 offset:16384
    ds_read_b64_tr_b16 v[254:255], v11 offset:17408
    s_waitcnt lgkmcnt(4)
    v_mfma_f32_32x32x16_bf16 v[112:127], v[244:247], v[152:155], v[112:127]
    ds_read_b64_tr_b16 v[240:241], v8 offset:24576
    ds_read_b64_tr_b16 v[242:243], v8 offset:25600
    s_add_u32 m0, s90, 131072
    s_mov_b32 s64, 745472
    buffer_load_dwordx4 v19, s[24:27], s64 offen lds
    s_waitcnt vmcnt(10) lgkmcnt(4)
    v_mfma_f32_32x32x16_bf16 v[96:111], v[248:251], v[156:159], v[96:111]
    ds_read_b64_tr_b16 v[244:245], v11 offset:24576
    ds_read_b64_tr_b16 v[246:247], v11 offset:25600
    s_waitcnt lgkmcnt(4)
    v_mfma_f32_32x32x16_bf16 v[112:127], v[252:255], v[156:159], v[112:127]
    ds_read_b64_tr_b16 v[248:249], v8 offset:32768
    ds_read_b64_tr_b16 v[250:251], v8 offset:33792
    s_add_u32 m0, s90, 139264
    s_mov_b32 s64, 802816
    buffer_load_dwordx4 v19, s[24:27], s64 offen lds
    s_waitcnt vmcnt(10) lgkmcnt(4)
    v_mfma_f32_32x32x16_bf16 v[96:111], v[240:243], v[160:163], v[96:111]
    ds_read_b64_tr_b16 v[252:253], v11 offset:32768
    ds_read_b64_tr_b16 v[254:255], v11 offset:33792
    s_waitcnt lgkmcnt(4)
    v_mfma_f32_32x32x16_bf16 v[112:127], v[244:247], v[160:163], v[112:127]
    ds_read_b64_tr_b16 v[240:241], v8 offset:40960
    ds_read_b64_tr_b16 v[242:243], v8 offset:41984
    s_add_u32 m0, s90, 147456
    s_mov_b32 s64, 917504
    buffer_load_dwordx4 v19, s[24:27], s64 offen lds
    s_waitcnt vmcnt(10) lgkmcnt(4)
    v_mfma_f32_32x32x16_bf16 v[96:111], v[248:251], v[164:167], v[96:111]
    ds_read_b64_tr_b16 v[244:245], v11 offset:40960
    ds_read_b64_tr_b16 v[246:247], v11 offset:41984
    s_waitcnt vmcnt(3)
    v_mov_b32 v24, s56
    v_mov_b32 v25, s57
    s_mov_b64 exec, 1
    buffer_store_dwordx2 v[24:25], off, s[32:35], s78 offset:512 sc1
    s_mov_b64 exec, -1
    buffer_load_dwordx2 v[28:29], v23, s[32:35], s77 offen sc1
    s_waitcnt lgkmcnt(4)
    v_mfma_f32_32x32x16_bf16 v[112:127], v[252:255], v[164:167], v[112:127]
    ds_read_b64_tr_b16 v[248:249], v8 offset:49152
    ds_read_b64_tr_b16 v[250:251], v8 offset:50176
    s_add_u32 m0, s90, 114688
    s_mov_b32 s64, 1032192
    buffer_load_dwordx4 v19, s[24:27], s64 offen lds
    s_waitcnt lgkmcnt(4)
    v_mfma_f32_32x32x16_bf16 v[96:111], v[240:243], v[168:171], v[96:111]
    s_barrier
    ds_read_b64_tr_b16 v[252:253], v11 offset:49152
    ds_read_b64_tr_b16 v[254:255], v11 offset:50176
    s_waitcnt lgkmcnt(4)
    v_mfma_f32_32x32x16_bf16 v[112:127], v[244:247], v[168:171], v[112:127]
    ds_read_b64_tr_b16 v[240:241], v8 offset:57344
    ds_read_b64_tr_b16 v[242:243], v8 offset:58368
    s_add_u32 m0, s90, 122880
    s_mov_b32 s64, 1146880
    buffer_load_dwordx4 v19, s[24:27], s64 offen lds
    s_waitcnt lgkmcnt(4)
    v_mfma_f32_32x32x16_bf16 v[96:111], v[248:251], v[172:175], v[96:111]
    ds_read_b64_tr_b16 v[244:245], v11 offset:57344
    ds_read_b64_tr_b16 v[246:247], v11 offset:58368
    s_waitcnt vmcnt(2)
    v_cmp_ne_u64 vcc, s[56:57], v[28:29]
    s_cbranch_vccnz L_slow_A0
L_res_A0:
    s_add_u32 s65, s73, 0
    buffer_load_dwordx4 v[176:179], v2, s[32:35], s65 offen sc1
    s_add_u32 s65, s73, 8192
    buffer_load_dwordx4 v[180:183], v2, s[32:35], s65 offen sc1
    s_add_u32 s65, s73, 16384
    buffer_load_dwordx4 v[184:187], v2, s[32:35], s65 offen sc1
    s_add_u32 s65, s73, 24576
    buffer_load_dwordx4 v[188:191], v2, s[32:35], s65 offen sc1
    s_add_u32 s65, s73, 28672
    buffer_load_dwordx4 v[192:195], v2, s[32:35], s65 offen sc1
    s_add_u32 s65, s73, 36864
    buffer_load_dwordx4 v[196:199], v2, s[32:35], s65 offen sc1
    s_waitcnt lgkmcnt(4)
    v_mfma_f32_32x32x16_bf16 v[112:127], v[252:255], v[172:175], v[112:127]
    ds_read_b64_tr_b16 v[248:249], v9 offset:0
    ds_read_b64_tr_b16 v[250:251], v9 offset:1024
    s_add_u32 s65, s73, 45056
    buffer_load_dwordx4 v[200:203], v2, s[32:35], s65 offen sc1
    s_add_u32 m0, s90, 0
    s_mov_b32 s64, 1204224
    buffer_load_dwordx4 v19, s[24:27], s64 offen lds
    s_waitcnt vmcnt(7) lgkmcnt(4)
    v_mfma_f32_32x32x16_bf16 v[96:111], v[240:243], v[176:179], v[96:111]
    ds_read_b64_tr_b16 v[252:253], v12 offset:0
    ds_read_b64_tr_b16 v[254:255], v12 offset:1024
    s_add_u32 s65, s73, 53248
    buffer_load_dwordx4 v[204:207], v2, s[32:35], s65 offen sc1
    s_waitcnt lgkmcnt(4)
    v_mfma_f32_32x32x16_bf16 v[112:127], v[244:247], v[176:179], v[112:127]
    ds_read_b64_tr_b16 v[240:241], v9 offset:8192
    ds_read_b64_tr_b16 v[242:243], v9 offset:9216
    s_add_u32 m0, s90, 8192
    s_mov_b32 s64, 1318912
    buffer_load_dwordx4 v19, s[24:27], s64 offen lds
    s_waitcnt vmcnt(8) lgkmcnt(4)
    v_mfma_f32_32x32x16_bf16 v[96:111], v[248:251], v[180:183], v[96:111]
    ds_read_b64_tr_b16 v[244:245], v12 offset:8192
    ds_read_b64_tr_b16 v[246:247], v12 offset:9216
    s_add_u32 s65, s73, 57344
    buffer_load_dwordx4 v[208:211], v2, s[32:35], s65 offen sc1
    s_waitcnt lgkmcnt(4)
    v_mfma_f32_32x32x16_bf16 v[112:127], v[252:255], v[180:183], v[112:127]
    ds_read_b64_tr_b16 v[248:249], v9 offset:16384
    ds_read_b64_tr_b16 v[250:251], v9 offset:17408
    s_add_u32 m0, s90, 16384
    s_mov_b32 s64, 1433600
    buffer_load_dwordx4 v19, s[24:27], s64 offen lds
    s_waitcnt vmcnt(9) lgkmcnt(4)
    v_mfma_f32_32x32x16_bf16 v[96:111], v[240:243], v[184:187], v[96:111]
    s_barrier
    ds_read_b64_tr_b16 v[252:253], v12 offset:16384
    ds_read_b64_tr_b16 v[254:255], v12 offset:17408
    s_add_u32 s65, s73, 65536
    buffer_load_dwordx4 v[212:215], v2, s[32:35], s65 offen sc1
    s_waitcnt lgkmcnt(4)
    v_mfma_f32_32x32x16_bf16 v[112:127], v[244:247], v[184:187], v[112:127]
    ds_read_b64_tr_b16 v[240:241], v9 offset:24576
    ds_read_b64_tr_b16 v[242:243], v9 offset:25600
    s_add_u32 s65, s73, 73728
    buffer_load_dwordx4 v[216:219], v2, s[32:35], s65 offen sc1
    s_add_u32 m0, s90, 24576
    s_mov_b32 s64, 1548288
    buffer_load_dwordx4 v19, s[24:27], s64 offen lds
    s_waitcnt vmcnt(11) lgkmcnt(4)
    v_mfma_f32_32x32x16_bf16 v[96:111], v[248:251], v[188:191], v[96:111]
    ds_read_b64_tr_b16 v[244:245], v12 offset:24576
    ds_read_b64_tr_b16 v[246:247], v12 offset:25600
    s_waitcnt lgkmcnt(4)
    v_mfma_f32_32x32x16_bf16 v[112:127], v[252:255], v[188:191], v[112:127]
    ds_read_b64_tr_b16 v[248:249], v9 offset:32768
    ds_read_b64_tr_b16 v[250:251], v9 offset:33792
    s_add_u32 s65, s73, 81920
    buffer_load_dwordx4 v[220:223], v2, s[32:35], s65 offen sc1
    s_add_u32 m0, s90, 32768
    s_mov_b32 s64, 0
    buffer_load_dwordx4 v19, s[28:31], s64 offen lds
    s_waitcnt vmcnt(12) lgkmcnt(4)
    v_mfma_f32_32x32x16_bf16 v[96:111], v[240:243], v[192:195], v[96:111]
    ds_read_b64_tr_b16 v[252:253], v12 offset:32768
    ds_read_b64_tr_b16 v[254:255], v12 offset:33792
    s_waitcnt lgkmcnt(4)
    v_mfma_f32_32x32x16_bf16 v[112:127], v[244:247], v[192:195], v[112:127]
    ds_read_b64_tr_b16 v[240:241], v9 offset:40960
    ds_read_b64_tr_b16 v[242:243], v9 offset:41984
    s_add_u32 s65, s73, 86016
    buffer_load_dwordx4 v[128:131], v2, s[32:35], s65 offen sc1
    s_add_u32 m0, s90, 40960
    s_mov_b32 s64, 50176
    buffer_load_dwordx4 v19, s[28:31], s64 offen lds
    s_waitcnt vmcnt(13) lgkmcnt(4)
    v_mfma_f32_32x32x16_bf16 v[96:111], v[248:251], v[196:199], v[96:111]
    ds_read_b64_tr_b16 v[244:245], v12 offset:40960
    ds_read_b64_tr_b16 v[246:247], v12 offset:41984
    s_add_u32 s65, s73, 94208
    buffer_load_dwordx4 v[132:135], v2, s[32:35], s65 offen sc1
    s_waitcnt lgkmcnt(4)
    v_mfma_f32_32x32x16_bf16 v[112:127], v[252:255], v[196:199], v[112:127]
    ds_read_b64_tr_b16 v[248:249], v10 offset:0
    ds_read_b64_tr_b16 v[250:251], v10 offset:1024
    s_add_u32 m0, s90, 49152
    s_mov_b32 s64, 100352
    buffer_load_dwordx4 v19, s[28:31], s64 offen lds
    s_waitcnt vmcnt(14) lgkmcnt(4)
    v_mfma_f32_32x32x16_bf16 v[96:111], v[240:243], v[200:203], v[96:111]
    s_barrier
    ds_read_b64_tr_b16 v[252:253], v13 offset:0
    ds_read_b64_tr_b16 v[254:255], v13 offset:1024
    s_add_u32 s65, s73, 102400
    buffer_load_dwordx4 v[136:139], v2, s[32:35], s65 offen sc1
    s_waitcnt lgkmcnt(4)
    v_mfma_f32_32x32x16_bf16 v[112:127], v[244:247], v[200:203], v[112:127]
    ds_read_b64_tr_b16 v[240:241], v10 offset:8192
    ds_read_b64_tr_b16 v[242:243], v10 offset:9216
    s_add_u32 m0, s90, 57344
    s_mov_b32 s64, 150528
    buffer_load_dwordx4 v19, s[28:31], s64 offen lds
    s_waitcnt vmcnt(14) lgkmcnt(4)
    v_mfma_f32_32x32x16_bf16 v[96:111], v[248:251], v[204:207], v[96:111]
    ds_read_b64_tr_b16 v[244:245], v13 offset:8192
    ds_read_b64_tr_b16 v[246:247], v13 offset:9216
    s_add_u32 s65, s73, 110592
    buffer_load_dwordx4 v[140:143], v2, s[32:35], s65 offen sc1
    s_waitcnt lgkmcnt(4)
    v_mfma_f32_32x32x16_bf16 v[112:127], v[252:255], v[204:207], v[112:127]
    ds_read_b64_tr_b16 v[248:249], v10 offset:16384
    ds_read_b64_tr_b16 v[250:251], v10 offset:17408
    s_add_u32 m0, s90, 65536
    s_mov_b32 s64, 200704
    buffer_load_dwordx4 v19, s[28:31], s64 offen lds
    s_waitcnt vmcnt(14) lgkmcnt(4)
    v_mfma_f32_32x32x16_bf16 v[96:111], v[240:243], v[208:211], v[96:111]
    ds_read_b64_tr_b16 v[252:253], v13 offset:16384
    ds_read_b64_tr_b16 v[254:255], v13 offset:17408
    buffer_load_dwordx2 v[26:27], v23, s[32:35], s69 offen sc1
    s_waitcnt lgkmcnt(4)
    v_mfma_f32_32x32x16_bf16 v[112:127], v[244:247], v[208:211], v[112:127]
    ds_read_b64_tr_b16 v[240:241], v9 offset:49152
    ds_read_b64_tr_b16 v[242:243], v9 offset:50176
    s_add_u32 m0, s90, 73728
    s_mov_b32 s64, 250880
    buffer_load_dwordx4 v19, s[28:31], s64 offen lds
    s_waitcnt vmcnt(14) lgkmcnt(4)
    v_mfma_f32_32x32x16_bf16 v[96:111], v[248:251], v[212:215], v[96:111]
    ds_read_b64_tr_b16 v[244:245], v12 offset:49152
    ds_read_b64_tr_b16 v[246:247], v12 offset:50176
    s_waitcnt lgkmcnt(4)
    v_mfma_f32_32x32x16_bf16 v[112:127], v[252:255], v[212:215], v[112:127]
    ds_read_b64_tr_b16 v[248:249], v9 offset:57344
    ds_read_b64_tr_b16 v[250:251], v9 offset:58368
    s_add_u32 m0, s90, 81920
    s_mov_b32 s64, 301056
    buffer_load_dwordx4 v19, s[28:31], s64 offen lds
    s_waitcnt vmcnt(14) lgkmcnt(4)
    v_mfma_f32_32x32x16_bf16 v[96:111], v[240:243], v[216:219], v[96:111]
    s_waitcnt vmcnt(13)
    s_barrier
    ds_read_b64_tr_b16 v[252:253], v12 offset:57344
    ds_read_b64_tr_b16 v[254:255], v12 offset:58368
    s_waitcnt vmcnt(2)
    v_cmp_ne_u64 vcc, s[56:57], v[26:27]
    s_cbranch_vccnz L_slow_O0
L_res_O0:
    s_add_u32 s65, s73, 114688
    buffer_load_dwordx4 v[144:147], v2, s[32:35], s65 offen sc1
    s_add_u32 s65, s73, 118784
    buffer_load_dwordx4 v[148:151], v2, s[32:35], s65 offen sc1
    s_waitcnt lgkmcnt(4)
    v_mfma_f32_32x32x16_bf16 v[112:127], v[244:247], v[216:219], v[112:127]
    ds_read_b64_tr_b16 v[240:241], v8 offset:0
    ds_read_b64_tr_b16 v[242:243], v8 offset:1024
    s_add_u32 s65, s73, 122880
    buffer_load_dwordx4 v[152:155], v2, s[32:35], s65 offen sc1
    s_add_u32 m0, s90, 90112
    s_mov_b32 s64, 351232
    buffer_load_dwordx4 v19, s[28:31], s64 offen lds
    s_waitcnt lgkmcnt(4)
    v_mfma_f32_32x32x16_bf16 v[96:111], v[248:251], v[220:223], v[96:111]
    ds_read_b64_tr_b16 v[244:245], v11 offset:0
    ds_read_b64_tr_b16 v[246:247], v11 offset:1024
    s_add_u32 s65, s73, 126976
    buffer_load_dwordx4 v[156:159], v2, s[32:35], s65 offen sc1
    s_waitcnt lgkmcnt(4)
    v_mfma_f32_32x32x16_bf16 v[112:127], v[252:255], v[220:223], v[112:127]
    ds_read_b64_tr_b16 v[248:249], v8 offset:8192
    ds_read_b64_tr_b16 v[250:251], v8 offset:9216
    s_add_u32 s65, s73, 131072
    buffer_load_dwordx4 v[160:163], v2, s[32:35], s65 offen sc1
    s_add_u32 s65, s73, 135168
    buffer_load_dwordx4 v[164:167], v2, s[32:35], s65 offen sc1
    s_waitcnt lgkmcnt(4)
    v_mfma_f32_32x32x16_bf16 v[96:111], v[240:243], v[128:131], v[96:111]
    ds_read_b64_tr_b16 v[252:253], v11 offset:8192
    ds_read_b64_tr_b16 v[254:255], v11 offset:9216
    s_add_u32 s65, s73, 139264
    buffer_load_dwordx4 v[168:171], v2, s[32:35], s65 offen sc1
    s_waitcnt lgkmcnt(4)
    v_mfma_f32_32x32x16_bf16 v[112:127], v[244:247], v[128:131], v[112:127]
    ds_read_b64_tr_b16 v[240:241], v8 offset:16384
    ds_read_b64_tr_b16 v[242:243], v8 offset:17408
    s_add_u32 s65, s73, 143360
    buffer_load_dwordx4 v[172:175], v2, s[32:35], s65 offen sc1
    s_waitcnt lgkmcnt(4)
    v_mfma_f32_32x32x16_bf16 v[96:111], v[248:251], v[132:135], v[96:111]
    ds_read_b64_tr_b16 v[244:245], v11 offset:16384
    ds_read_b64_tr_b16 v[246:247], v11 offset:17408
    s_waitcnt lgkmcnt(4)
    v_mfma_f32_32x32x16_bf16 v[112:127], v[252:255], v[132:135], v[112:127]
    ds_read_b64_tr_b16 v[248:249], v8 offset:24576
    ds_read_b64_tr_b16 v[250:251], v8 offset:25600
    s_waitcnt lgkmcnt(4)
    v_mfma_f32_32x32x16_bf16 v[96:111], v[240:243], v[136:139], v[96:111]
    s_barrier
    ds_read_b64_tr_b16 v[252:253], v11 offset:24576
    ds_read_b64_tr_b16 v[254:255], v11 offset:25600
    s_waitcnt lgkmcnt(4)
    v_mfma_f32_32x32x16_bf16 v[112:127], v[244:247], v[136:139], v[112:127]
    ds_read_b64_tr_b16 v[240:241], v14 offset:0
    ds_read_b64_tr_b16 v[242:243], v15 offset:0
    s_waitcnt lgkmcnt(4)
    v_mfma_f32_32x32x16_bf16 v[96:111], v[248:251], v[140:143], v[96:111]
    ds_read_b64_tr_b16 v[244:245], v16 offset:0
    ds_read_b64_tr_b16 v[246:247], v17 offset:0
    buffer_load_dwordx4 v[236:239], v18, s[8:11], 0 offen
    s_waitcnt lgkmcnt(4)
    v_mfma_f32_32x32x16_bf16 v[112:127], v[252:255], v[140:143], v[112:127]
    ds_read_b64_tr_b16 v[248:249], v14 offset:8192
    ds_read_b64_tr_b16 v[250:251], v15 offset:8192
    s_waitcnt vmcnt(9) lgkmcnt(4)
    v_mfma_f32_32x32x16_bf16 v[32:47], v[240:243], v[144:147], 0
    ds_read_b64_tr_b16 v[252:253], v16 offset:8192
    ds_read_b64_tr_b16 v[254:255], v17 offset:8192
    s_waitcnt lgkmcnt(4)
    v_mfma_f32_32x32x16_bf16 v[48:63], v[244:247], v[144:147], 0
    ds_read_b64_tr_b16 v[240:241], v14 offset:16384
    ds_read_b64_tr_b16 v[242:243], v15 offset:16384
    s_waitcnt vmcnt(8) lgkmcnt(4)
    v_mfma_f32_32x32x16_bf16 v[32:47], v[248:251], v[148:151], v[32:47]
    ds_read_b64_tr_b16 v[244:245], v16 offset:16384
    ds_read_b64_tr_b16 v[246:247], v17 offset:16384
    s_waitcnt lgkmcnt(4)
    v_mfma_f32_32x32x16_bf16 v[48:63], v[252:255], v[148:151], v[48:63]
    ds_read_b64_tr_b16 v[248:249], v14 offset:24576
    ds_read_b64_tr_b16 v[250:251], v15 offset:24576
    s_waitcnt vmcnt(7) lgkmcnt(4)
    v_mfma_f32_32x32x16_bf16 v[32:47], v[240:243], v[152:155], v[32:47]
    s_waitcnt vmcnt(6)
    s_barrier
    ds_read_b64_tr_b16 v[252:253], v16 offset:24576
    ds_read_b64_tr_b16 v[254:255], v17 offset:24576
    s_waitcnt lgkmcnt(4)
    v_mfma_f32_32x32x16_bf16 v[48:63], v[244:247], v[152:155], v[48:63]
    ds_read_b64_tr_b16 v[240:241], v14 offset:32768
    ds_read_b64_tr_b16 v[242:243], v15 offset:32768
    s_mul_i32 s66, s58, 6144
    s_add_u32 s66, s66, 0
    v_add_u32 v25, s66, v2
    v_add_u32 v24, 0, v2
    s_cmp_lg_u32 s58, 0
    s_cbranch_scc1 L_redY0_1
    ds_write_b128 v24, v[104:107] offset:6144
    ds_write_b128 v24, v[108:111] offset:7168
    ds_write_b128 v24, v[112:115] offset:12288
    ds_write_b128 v24, v[116:119] offset:13312
    ds_write_b128 v24, v[120:123] offset:18432
    ds_write_b128 v24, v[124:127] offset:19456
    v_mov_b64 v[64:65], v[96:97]
    v_mov_b64 v[66:67], v[98:99]
    v_mov_b64 v[68:69], v[100:101]
    v_mov_b64 v[70:71], v[102:103]
    s_branch L_redY0_4
L_redY0_1:
    s_cmp_lg_u32 s58, 1
    s_cbranch_scc1 L_redY0_2
    ds_write_b128 v24, v[96:99] offset:0
    ds_write_b128 v24, v[100:103] offset:1024
    ds_write_b128 v24, v[112:115] offset:14336
    ds_write_b128 v24, v[116:119] offset:15360
    ds_write_b128 v24, v[120:123] offset:20480
    ds_write_b128 v24, v[124:127] offset:21504
    v_mov_b64 v[64:65], v[104:105]
    v_mov_b64 v[66:67], v[106:107]
    v_mov_b64 v[68:69], v[108:109]
    v_mov_b64 v[70:71], v[110:111]
    s_branch L_redY0_4
L_redY0_2:
    s_cmp_lg_u32 s58, 2
    s_cbranch_scc1 L_redY0_3
    ds_write_b128 v24, v[96:99] offset:2048
    ds_write_b128 v24, v[100:103] offset:3072
    ds_write_b128 v24, v[104:107] offset:8192
    ds_write_b128 v24, v[108:111] offset:9216
    ds_write_b128 v24, v[120:123] offset:22528
    ds_write_b128 v24, v[124:127] offset:23552
    v_mov_b64 v[64:65], v[112:113]
    v_mov_b64 v[66:67], v[114:115]
    v_mov_b64 v[68:69], v[116:117]
    v_mov_b64 v[70:71], v[118:119]
    s_branch L_redY0_4
L_redY0_3:
    ds_write_b128 v24, v[96:99] offset:4096
    ds_write_b128 v24, v[100:103] offset:5120
    ds_write_b128 v24, v[104:107] offset:10240
    ds_write_b128 v24, v[108:111] offset:11264
    ds_write_b128 v24, v[112:115] offset:16384
    ds_write_b128 v24, v[116:119] offset:17408
    v_mov_b64 v[64:65], v[120:121]
    v_mov_b64 v[66:67], v[122:123]
    v_mov_b64 v[68:69], v[124:125]
    v_mov_b64 v[70:71], v[126:127]
L_redY0_4:
    s_waitcnt vmcnt(5) lgkmcnt(10)
    v_mfma_f32_32x32x16_bf16 v[32:47], v[248:251], v[156:159], v[32:47]
    ds_read_b64_tr_b16 v[244:245], v16 offset:32768
    ds_read_b64_tr_b16 v[246:247], v17 offset:32768
    s_waitcnt lgkmcnt(10)
    v_mfma_f32_32x32x16_bf16 v[48:63], v[252:255], v[156:159], v[48:63]
    ds_read_b64_tr_b16 v[248:249], v14 offset:40960
    ds_read_b64_tr_b16 v[250:251], v15 offset:40960
    s_waitcnt vmcnt(4) lgkmcnt(10)
    v_mfma_f32_32x32x16_bf16 v[32:47], v[240:243], v[160:163], v[32:47]
    ds_read_b64_tr_b16 v[252:253], v16 offset:40960
    ds_read_b64_tr_b16 v[254:255], v17 offset:40960
    s_waitcnt lgkmcnt(4)
    v_mfma_f32_32x32x16_bf16 v[48:63], v[244:247], v[160:163], v[48:63]
    ds_read_b64_tr_b16 v[240:241], v14 offset:49152
    ds_read_b64_tr_b16 v[242:243], v15 offset:49152
    s_waitcnt vmcnt(3) lgkmcnt(4)
    v_mfma_f32_32x32x16_bf16 v[32:47], v[248:251], v[164:167], v[32:47]
    ds_read_b64_tr_b16 v[244:245], v16 offset:49152
    ds_read_b64_tr_b16 v[246:247], v17 offset:49152
    s_barrier
    s_waitcnt lgkmcnt(4)
    v_mfma_f32_32x32x16_bf16 v[48:63], v[252:255], v[164:167], v[48:63]
    ds_read_b64_tr_b16 v[248:249], v14 offset:57344
    ds_read_b64_tr_b16 v[250:251], v15 offset:57344
    ds_read_b128 v[184:187], v25 offset:0
    ds_read_b128 v[188:191], v25 offset:1024
    ds_read_b128 v[192:195], v25 offset:2048
    ds_read_b128 v[196:199], v25 offset:3072
    ds_read_b128 v[200:203], v25 offset:4096
    ds_read_b128 v[204:207], v25 offset:5120
    s_mul_i32 s66, s58, 6144
    s_add_u32 s66, s66, 32768
    v_add_u32 v26, s66, v2
    s_waitcnt vmcnt(2) lgkmcnt(10)
    v_mfma_f32_32x32x16_bf16 v[32:47], v[240:243], v[168:171], v[32:47]
    ds_read_b64_tr_b16 v[252:253], v16 offset:57344
    ds_read_b64_tr_b16 v[254:255], v17 offset:57344
    v_add_u32 v24, 32768, v2
    s_waitcnt vmcnt(0)
    v_permlane32_swap_b32 v236, v238
    v_permlane32_swap_b32 v237, v239
    v_lshlrev_b32 v88, 16, v236
    v_and_b32 v89, 0xffff0000, v236
    v_lshlrev_b32 v90, 16, v237
    s_waitcnt lgkmcnt(10)
    v_mfma_f32_32x32x16_bf16 v[48:63], v[244:247], v[168:171], v[48:63]
    v_and_b32 v91, 0xffff0000, v237
    v_lshlrev_b32 v92, 16, v238
    v_and_b32 v93, 0xffff0000, v238
    v_lshlrev_b32 v94, 16, v239
    v_and_b32 v95, 0xffff0000, v239
    s_waitcnt lgkmcnt(3)
    v_add_f32 v192, v192, v200
    v_add_f32 v193, v193, v201
    v_mfma_f32_32x32x16_bf16 v[32:47], v[248:251], v[172:175], v[32:47]
    v_add_f32 v194, v194, v202
    v_add_f32 v195, v195, v203
    s_waitcnt lgkmcnt(2)
    v_add_f32 v196, v196, v204
    v_add_f32 v197, v197, v205
    v_add_f32 v198, v198, v206
    v_add_f32 v199, v199, v207
    v_add_f32 v64, v64, v184
    s_waitcnt lgkmcnt(0)
    v_mfma_f32_32x32x16_bf16 v[48:63], v[252:255], v[172:175], v[48:63]
    v_add_f32 v65, v65, v185
    v_add_f32 v66, v66, v186
    v_add_f32 v67, v67, v187
    v_add_f32 v68, v68, v188
    v_add_f32 v69, v69, v189
    v_add_f32 v70, v70, v190
    v_add_f32 v71, v71, v191
    v_pk_add_f32 v[64:65], v[64:65], v[192:193]
    v_pk_add_f32 v[66:67], v[66:67], v[194:195]
    v_pk_add_f32 v[68:69], v[68:69], v[196:197]
    v_pk_add_f32 v[70:71], v[70:71], v[198:199]
    v_pk_mul_f32 v[80:81], v[64:65], s[62:63] op_sel_hi:[1,0] neg_lo:[1,0] neg_hi:[1,0]
    v_pk_mul_f32 v[82:83], v[66:67], s[62:63] op_sel_hi:[1,0] neg_lo:[1,0] neg_hi:[1,0]
    v_pk_mul_f32 v[84:85], v[68:69], s[62:63] op_sel_hi:[1,0] neg_lo:[1,0] neg_hi:[1,0]
    v_pk_mul_f32 v[86:87], v[70:71], s[62:63] op_sel_hi:[1,0] neg_lo:[1,0] neg_hi:[1,0]
    s_nop 3
    s_cmp_lg_u32 s58, 0
    s_cbranch_scc1 L_redS0_1
    ds_write_b128 v24, v[40:43] offset:6144
    ds_write_b128 v24, v[44:47] offset:7168
    ds_write_b128 v24, v[48:51] offset:12288
    ds_write_b128 v24, v[52:55] offset:13312
    ds_write_b128 v24, v[56:59] offset:18432
    ds_write_b128 v24, v[60:63] offset:19456
    v_mov_b64 v[72:73], v[32:33]
    v_mov_b64 v[74:75], v[34:35]
    v_mov_b64 v[76:77], v[36:37]
    v_mov_b64 v[78:79], v[38:39]
    s_branch L_redS0_4
L_redS0_1:
    s_cmp_lg_u32 s58, 1
    s_cbranch_scc1 L_redS0_2
    ds_write_b128 v24, v[32:35] offset:0
    ds_write_b128 v24, v[36:39] offset:1024
    ds_write_b128 v24, v[48:51] offset:14336
    ds_write_b128 v24, v[52:55] offset:15360
    ds_write_b128 v24, v[56:59] offset:20480
    ds_write_b128 v24, v[60:63] offset:21504
    v_mov_b64 v[72:73], v[40:41]
    v_mov_b64 v[74:75], v[42:43]
    v_mov_b64 v[76:77], v[44:45]
    v_mov_b64 v[78:79], v[46:47]
    s_branch L_redS0_4
L_redS0_2:
    s_cmp_lg_u32 s58, 2
    s_cbranch_scc1 L_redS0_3
    ds_write_b128 v24, v[32:35] offset:2048
    ds_write_b128 v24, v[36:39] offset:3072
    ds_write_b128 v24, v[40:43] offset:8192
    ds_write_b128 v24, v[44:47] offset:9216
    ds_write_b128 v24, v[56:59] offset:22528
    ds_write_b128 v24, v[60:63] offset:23552
    v_mov_b64 v[72:73], v[48:49]
    v_mov_b64 v[74:75], v[50:51]
    v_mov_b64 v[76:77], v[52:53]
    v_mov_b64 v[78:79], v[54:55]
    s_branch L_redS0_4
L_redS0_3:
    ds_write_b128 v24, v[32:35] offset:4096
    ds_write_b128 v24, v[36:39] offset:5120
    ds_write_b128 v24, v[40:43] offset:10240
    ds_write_b128 v24, v[44:47] offset:11264
    ds_write_b128 v24, v[48:51] offset:16384
    ds_write_b128 v24, v[52:55] offset:17408
    v_mov_b64 v[72:73], v[56:57]
    v_mov_b64 v[74:75], v[58:59]
    v_mov_b64 v[76:77], v[60:61]
    v_mov_b64 v[78:79], v[62:63]
L_redS0_4:
    v_exp_f32 v80, v80
    v_exp_f32 v81, v81
    v_exp_f32 v82, v82
    v_exp_f32 v83, v83
    v_exp_f32 v84, v84
    v_exp_f32 v85, v85
    v_exp_f32 v86, v86
    v_exp_f32 v87, v87
    v_pk_add_f32 v[80:81], v[80:81], 1.0 op_sel_hi:[1,0]
    v_pk_add_f32 v[82:83], v[82:83], 1.0 op_sel_hi:[1,0]
    v_pk_add_f32 v[84:85], v[84:85], 1.0 op_sel_hi:[1,0]
    v_pk_add_f32 v[86:87], v[86:87], 1.0 op_sel_hi:[1,0]
    v_rcp_f32 v80, v80
    v_rcp_f32 v81, v81
    v_rcp_f32 v82, v82
    v_rcp_f32 v83, v83
    v_rcp_f32 v84, v84
    v_rcp_f32 v85, v85
    v_rcp_f32 v86, v86
    v_rcp_f32 v87, v87
    v_pk_mul_f32 v[80:81], v[80:81], v[64:65]
    v_pk_mul_f32 v[82:83], v[82:83], v[66:67]
    v_pk_mul_f32 v[84:85], v[84:85], v[68:69]
    v_pk_mul_f32 v[86:87], v[86:87], v[70:71]
    s_waitcnt lgkmcnt(0)
    s_barrier
    ds_read_b128 v[128:131], v26 offset:0
    ds_read_b128 v[132:135], v26 offset:1024
    ds_read_b128 v[136:139], v26 offset:2048
    ds_read_b128 v[140:143], v26 offset:3072
    ds_read_b128 v[144:147], v26 offset:4096
    ds_read_b128 v[148:151], v26 offset:5120
    v_pk_fma_f32 v[88:89], v[72:73], v[80:81], v[88:89]
    v_pk_fma_f32 v[90:91], v[74:75], v[82:83], v[90:91]
    v_pk_fma_f32 v[92:93], v[76:77], v[84:85], v[92:93]
    v_pk_fma_f32 v[94:95], v[78:79], v[86:87], v[94:95]
    s_waitcnt lgkmcnt(5)
    v_pk_fma_f32 v[88:89], v[128:129], v[80:81], v[88:89]
    v_pk_fma_f32 v[90:91], v[130:131], v[82:83], v[90:91]
    s_waitcnt lgkmcnt(4)
    v_pk_fma_f32 v[92:93], v[132:133], v[84:85], v[92:93]
    v_pk_fma_f32 v[94:95], v[134:135], v[86:87], v[94:95]
    s_waitcnt lgkmcnt(3)
    v_pk_fma_f32 v[88:89], v[136:137], v[80:81], v[88:89]
    v_pk_fma_f32 v[90:91], v[138:139], v[82:83], v[90:91]
    s_waitcnt lgkmcnt(2)
    v_pk_fma_f32 v[92:93], v[140:141], v[84:85], v[92:93]
    v_pk_fma_f32 v[94:95], v[142:143], v[86:87], v[94:95]
    s_waitcnt lgkmcnt(1)
    v_pk_fma_f32 v[88:89], v[144:145], v[80:81], v[88:89]
    v_pk_fma_f32 v[90:91], v[146:147], v[82:83], v[90:91]
    s_waitcnt lgkmcnt(0)
    v_pk_fma_f32 v[92:93], v[148:149], v[84:85], v[92:93]
    v_pk_fma_f32 v[94:95], v[150:151], v[86:87], v[94:95]
    v_cvt_pk_bf16_f32 v80, v88, v89
    v_cvt_pk_bf16_f32 v81, v90, v91
    v_cvt_pk_bf16_f32 v82, v92, v93
    v_cvt_pk_bf16_f32 v83, v94, v95
    s_nop 0
    v_permlane32_swap_b32 v80, v82
    v_permlane32_swap_b32 v81, v83
    buffer_store_dwordx4 v[80:83], v18, s[36:39], 0 offen
    s_or_b32 s65, s2, s48
    s_cmp_lg_u32 s65, 0
    s_cbranch_scc1 L_end
    v_mov_b32 v24, s56
    v_mov_b32 v25, s57
    s_mov_b64 exec, 1
    buffer_store_dwordx2 v[24:25], off, s[32:35], 0 offset:0 sc1
    s_mov_b64 exec, -1
    s_endpgm
L_half1:
    s_lshl_b32 s65, s58, 4
    v_lshrrev_b32 v53, 2, v1
    v_add_u32 v53, s65, v53
    v_mul_u32_u24 v8, 2688, v53
    v_and_b32 v53, 3, v1
    v_lshlrev_b32 v53, 4, v53
    v_min_u32 v53, 40, v53
    s_mul_i32 s65, s50, 56
    v_add3_u32 v8, v8, v53, s65
    s_add_u32 m0, s54, 114688
    s_bfe_u32 s64, s53, 0x00040000
    s_mul_i32 s64, s64, 172032
    s_add_u32 s64, s64, 1792
    buffer_load_dwordx4 v8, s[12:15], s64 offen lds
    v_and_b32 v53, 31, v1
    v_lshrrev_b32 v54, 5, v1
    v_bfe_u32 v49, v1, 1, 3
    v_xor_b32 v49, v49, v54
    v_lshlrev_b32 v53, 7, v53
    s_add_u32 m0, s54, 16384
    s_bfe_u32 s64, s53, 0x00040004
    s_lshl_b32 s64, s64, 7
    buffer_load_dwordx4 v31, s[8:11], s64 offen lds
    s_lshl_b32 s65, s58, 12
    v_add_u32 v53, s65, v53
    s_mov_b32 s70, 0x3f803f80
    v_xor_b32 v24, 0, v49
    v_lshl_add_u32 v24, v24, 4, v53
    v_xor_b32 v25, 2, v49
    s_add_u32 m0, s54, 24576
    s_add_u32 s64, s64, 57344
    buffer_load_dwordx4 v31, s[8:11], s64 offen lds
    v_lshl_add_u32 v25, v25, 4, v53
    v_xor_b32 v26, 4, v49
    v_lshl_add_u32 v26, v26, 4, v53
    v_xor_b32 v27, 6, v49
    s_add_u32 m0, s54, 122880
    s_bfe_u32 s64, s53, 0x00040004
    s_mul_i32 s64, s64, 172032
    s_add_u32 s64, s64, 1792
    buffer_load_dwordx4 v8, s[12:15], s64 offen lds
    v_lshl_add_u32 v27, v27, 4, v53
    v_bfe_u32 v39, v1, 4, 1
    v_bfe_u32 v36, v1, 2, 2
    v_lshrrev_b32 v37, 5, v1
    s_add_u32 m0, s54, 32768
    s_bfe_u32 s64, s53, 0x00040008
    s_lshl_b32 s64, s64, 7
    buffer_load_dwordx4 v31, s[8:11], s64 offen lds
    v_and_b32 v38, 3, v1
    v_lshl_add_u32 v37, v37, 3, v36
    v_lshlrev_b32 v11, 6, v37
    v_lshl_add_u32 v11, v39, 5, v11
    v_lshl_add_u32 v11, v38, 3, v11
    s_add_u32 m0, s54, 40960
    s_add_u32 s64, s64, 57344
    buffer_load_dwordx4 v31, s[8:11], s64 offen lds
    v_add_u32 v11, 118784, v11
    s_lshl_b32 s65, s58, 10
    v_add_u32 v14, s65, v11
    v_lshrrev_b32 v35, 2, v1
    v_xor_b32 v35, v35, v39
    s_add_u32 m0, s54, 131072
    s_bfe_u32 s64, s53, 0x00040008
    s_mul_i32 s64, s64, 172032
    s_add_u32 s64, s64, 1792
    buffer_load_dwordx4 v8, s[12:15], s64 offen lds
    v_and_b32 v35, 1, v35
    v_cmp_eq_u32 vcc, 0, v35
    v_mov_b32 v35, s70
    s_nop 0
    v_cndmask_b32 v240, 0, v35, vcc
    v_mov_b32 v241, v240
    v_mov_b32 v242, v240
    v_mov_b32 v243, v240
    s_mov_b32 s18, 1605632
    s_mov_b32 s19, 0x20000
    s_mov_b32 s22, 1605632
    s_mov_b32 s23, 0x20000
    s_mov_b32 s42, 25088
    s_mov_b32 s43, 0x20000
    s_mov_b32 s30, 401408
    s_mov_b32 s31, 0x20000
    s_mov_b32 s26, 1605632
    s_mov_b32 s27, 0x20000
    s_mov_b32 s38, 1835008
    s_mov_b32 s39, 0x20000
    s_mov_b32 s34, 11796480
    s_mov_b32 s35, 0x20000
    s_lshl_b32 s90, s58, 10
    s_waitcnt lgkmcnt(0)
    s_mov_b32 s66, 0x67542310
    s_mov_b32 s67, 0xfecdba89
    s_lshl_b32 s65, s50, 2
    s_lshr_b64 s[66:67], s[66:67], s65
    s_and_b32 s51, s66, 15
    s_and_b32 s52, s51, 3
    s_cmp_eq_u32 s58, 0
    s_cselect_b32 s44, s16, s20
    s_cselect_b32 s45, s17, s21
    s_cselect_b32 s65, 0, 4
    s_cselect_b32 s66, 3, s58
    s_lshl_b32 s55, s58, 11
    s_add_u32 s55, s55, 4096
    s_lshl_b32 s66, s66, 7
    s_sub_u32 s66, s66, 128
    s_mov_b32 s46, 1605632
    s_mov_b32 s47, 0x20000
    s_mul_i32 s67, s51, 224
    v_add_u32 v53, s66, v1
    v_mul_u32_u24 v54, 683, v53
    v_lshrrev_b32 v54, 12, v54
    v_mul_u32_u24 v55, 6, v54
    v_sub_u32 v55, v53, v55
    v_xor_b32 v54, s65, v54
    v_mul_u32_u24 v9, 3584, v54
    v_lshrrev_b32 v54, 1, v55
    v_add_u32 v53, 4, v54
    v_cmp_gt_u32 vcc, s52, v54
    v_and_b32 v55, 1, v55
    s_nop 0
    v_cndmask_b32 v54, v53, v54, vcc
    v_lshl_or_b32 v54, v54, 1, v55
    v_lshlrev_b32 v54, 4, v54
    v_add3_u32 v9, v9, v54, s67
    s_add_u32 s66, s66, 64
    v_add_u32 v53, s66, v1
    v_mul_u32_u24 v54, 683, v53
    v_lshrrev_b32 v54, 12, v54
    v_mul_u32_u24 v55, 6, v54
    v_sub_u32 v55, v53, v55
    v_xor_b32 v54, s65, v54
    v_mul_u32_u24 v10, 3584, v54
    v_lshrrev_b32 v54, 1, v55
    v_add_u32 v53, 4, v54
    v_cmp_gt_u32 vcc, s52, v54
    v_and_b32 v55, 1, v55
    s_nop 0
    v_cndmask_b32 v54, v53, v54, vcc
    v_lshl_or_b32 v54, v54, 1, v55
    v_lshlrev_b32 v54, 4, v54
    v_add3_u32 v10, v10, v54, s67
    s_lshl_b32 s66, s58, 6
    s_mov_b32 s65, 0
    v_add_u32 v53, s66, v1
    v_mul_u32_u24 v54, 683, v53
    v_lshrrev_b32 v54, 12, v54
    v_mul_u32_u24 v55, 6, v54
    v_sub_u32 v55, v53, v55
    v_xor_b32 v54, s65, v54
    v_mul_u32_u24 v22, 3584, v54
    v_lshrrev_b32 v54, 1, v55
    v_add_u32 v53, 4, v54
    v_cmp_gt_u32 vcc, s52, v54
    v_and_b32 v55, 1, v55
    s_nop 0
    v_cndmask_b32 v54, v53, v54, vcc
    v_lshl_or_b32 v54, v54, 1, v55
    v_lshlrev_b32 v54, 4, v54
    v_add3_u32 v22, v22, v54, s67
    s_lshl_b32 s65, s58, 3
    v_add_u32 v53, s65, v50
    v_bfe_u32 v51, v1, 4, 1
    v_lshlrev_b32 v49, 1, v51
    v_xor_b32 v49, v49, v52
    s_lshl_b32 s66, s52, 5
    s_add_u32 s66, s66, s67
    v_mul_u32_u24 v19, 3584, v53
    v_add_u32 v19, s66, v19
    v_lshl_add_u32 v17, v49, 4, v19
    v_xor_b32 v49, 4, v49
    v_lshl_add_u32 v18, v49, 4, v19
    s_mul_i32 s66, s61, 37
    s_lshr_b32 s66, s66, 8
    s_mul_i32 s67, s66, 7
    s_sub_u32 s75, s61, s67
    s_lshl_b32 s67, s60, 2
    s_add_u32 s66, s66, s67
    s_lshl_b32 s66, s66, 1
    s_add_u32 s76, s66, 1
    s_and_b32 s76, s76, 63
    v_lshlrev_b32 v49, 2, v51
    v_xor_b32 v49, v49, v52
    v_mul_u32_u24 v53, 896, v53
    s_lshl_b32 s66, s75, 7
    v_add_u32 v53, s66, v53
    v_lshl_add_u32 v19, v49, 4, v53
    v_lshlrev_b32 v2, 4, v1
    v_cmp_lt_u32 vcc, 31, v1
    v_mov_b32 v248, 0
    v_mov_b32 v249, 0
    v_cndmask_b32 v3, 0, 1.0, vcc
    s_mov_b32 s62, 0x3fb8aa3b
    s_mov_b32 s71, 0x00003f80
    s_mov_b32 s72, 0x3f800000
    s_lshl_b32 s59, s49, 2
    s_add_u32 s59, s59, s58
    s_mul_i32 s63, s59, 151552
    s_add_u32 s63, s63, 2097152
    s_lshl_b32 s78, s59, 10
    s_lshl_b32 s66, s51, 3
    s_add_u32 s78, s78, s66
    s_add_u32 s78, s78, 65536
    s_mul_i32 s73, s76, 151552
    s_lshl_b32 s66, s58, 10
    s_add_u32 s73, s73, s66
    s_add_u32 s73, s73, 2097152
    s_lshl_b32 s74, s76, 10
    s_add_u32 s74, s74, 65536
    s_lshr_b32 s77, s58, 1
    s_add_u32 s77, s77, 2
    s_lshl_b32 s77, s77, 7
    s_add_u32 s77, s77, s74
    s_lshl_b32 s82, s50, 2
    s_add_u32 s82, s82, s58
    s_lshl_b32 s82, s82, 7
    s_add_u32 s82, s82, 4096
    s_mov_b32 s66, 20480
    v_xor_b32 v49, 0, v39
    v_lshl_add_u32 v49, v49, 2, v37
    v_mul_u32_u24 v49, 96, v49
    v_mul_u32_u24 v12, 6144, v39
    v_lshl_add_u32 v49, v38, 3, v49
    v_add3_u32 v12, v12, v49, s66
    v_xor_b32 v49, 1, v39
    v_lshl_add_u32 v49, v49, 2, v37
    v_mul_u32_u24 v49, 96, v49
    v_mul_u32_u24 v13, 6144, v39
    v_lshl_add_u32 v49, v38, 3, v49
    v_add3_u32 v13, v13, v49, s66
    v_lshrrev_b32 v49, 1, v36
    v_lshl_or_b32 v49, v39, 1, v49
    v_lshlrev_b32 v37, 7, v37
    v_lshl_add_u32 v37, v39, 13, v37
    v_lshl_add_u32 v37, v38, 3, v37
    v_xor_b32 v20, 2, v49
    v_lshl_add_u32 v20, v20, 5, v37
    v_xor_b32 v21, 3, v49
    v_lshl_add_u32 v21, v21, 5, v37
    s_mul_i32 s65, s58, 1536
    v_add_u32 v15, s65, v12
    v_add_u32 v16, s65, v13
    v_mov_b32 v28, 0
    v_mov_b32 v29, 0
    s_waitcnt vmcnt(6)
    s_barrier
    ds_read_b128 v[128:131], v24 offset:0
    ds_read_b64_tr_b16 v[80:81], v11 offset:0
    ds_read_b64_tr_b16 v[82:83], v11 offset:256
    ds_read_b128 v[132:135], v25 offset:0
    ds_read_b64_tr_b16 v[84:85], v11 offset:1024
    ds_read_b64_tr_b16 v[86:87], v11 offset:1280
    ds_read_b128 v[136:139], v26 offset:0
    ds_read_b64_tr_b16 v[88:89], v11 offset:2048
    ds_read_b64_tr_b16 v[90:91], v11 offset:2304
    ds_read_b128 v[140:143], v27 offset:0
    ds_read_b64_tr_b16 v[92:93], v11 offset:3072
    ds_read_b64_tr_b16 v[94:95], v11 offset:3328
    ds_read_b64_tr_b16 v[250:251], v14 offset:0
    ds_read_b64_tr_b16 v[252:253], v14 offset:256
    s_waitcnt lgkmcnt(0)
    s_waitcnt vmcnt(3)
    s_barrier
    v_mfma_f32_32x32x16_bf16 v[64:79], v[80:83], v[128:131], 0
    s_add_u32 m0, s54, 49152
    s_bfe_u32 s64, s53, 0x0004000c
    s_lshl_b32 s64, s64, 7
    buffer_load_dwordx4 v31, s[8:11], s64 offen lds
    v_mfma_f32_16x16x32_bf16 v[56:59], v[240:243], v[250:253], 0
    ds_read_b128 v[144:147], v24 offset:16384
    ds_read_b64_tr_b16 v[96:97], v11 offset:8192
    ds_read_b64_tr_b16 v[98:99], v11 offset:8448
    ds_read_b128 v[148:151], v25 offset:16384
    v_mfma_f32_32x32x16_bf16 v[64:79], v[84:87], v[132:135], v[64:79]
    ds_read_b64_tr_b16 v[100:101], v11 offset:9216
    ds_read_b64_tr_b16 v[102:103], v11 offset:9472
    ds_read_b128 v[152:155], v26 offset:16384
    v_mfma_f32_32x32x16_bf16 v[64:79], v[88:91], v[136:139], v[64:79]
    s_add_u32 m0, s54, 57344
    s_add_u32 s64, s64, 57344
    buffer_load_dwordx4 v31, s[8:11], s64 offen lds
    ds_read_b64_tr_b16 v[104:105], v11 offset:10240
    ds_read_b64_tr_b16 v[106:107], v11 offset:10496
    ds_read_b128 v[156:159], v27 offset:16384
    ds_read_b64_tr_b16 v[108:109], v11 offset:11264
    v_mfma_f32_32x32x16_bf16 v[64:79], v[92:95], v[140:143], v[64:79]
    ds_read_b64_tr_b16 v[110:111], v11 offset:11520
    ds_read_b64_tr_b16 v[250:251], v14 offset:8192
    ds_read_b64_tr_b16 v[252:253], v14 offset:8448
    v_dot2c_f32_bf16 v28, s70, v136
    v_dot2c_f32_bf16 v29, v136, v136
    s_add_u32 m0, s54, 139264
    s_bfe_u32 s64, s53, 0x0004000c
    s_mul_i32 s64, s64, 172032
    s_add_u32 s64, s64, 1792
    buffer_load_dwordx4 v8, s[12:15], s64 offen lds
    v_dot2c_f32_bf16 v28, s70, v137
    v_dot2c_f32_bf16 v29, v137, v137
    v_dot2c_f32_bf16 v28, s70, v138
    v_dot2c_f32_bf16 v29, v138, v138
    v_dot2c_f32_bf16 v28, s70, v139
    v_dot2c_f32_bf16 v29, v139, v139
    v_dot2c_f32_bf16 v28, s70, v140
    v_dot2c_f32_bf16 v29, v140, v140
    v_dot2c_f32_bf16 v28, s70, v141
    v_dot2c_f32_bf16 v29, v141, v141
    v_dot2c_f32_bf16 v28, s70, v142
    v_dot2c_f32_bf16 v29, v142, v142
    v_dot2c_f32_bf16 v28, s70, v143
    v_dot2c_f32_bf16 v29, v143, v143
    s_waitcnt lgkmcnt(0)
    s_waitcnt vmcnt(3)
    s_barrier
    v_mfma_f32_32x32x16_bf16 v[64:79], v[96:99], v[144:147], v[64:79]
    s_add_u32 m0, s54, 65536
    s_bfe_u32 s64, s53, 0x00040010
    s_lshl_b32 s64, s64, 7
    buffer_load_dwordx4 v31, s[8:11], s64 offen lds
    v_mfma_f32_16x16x32_bf16 v[56:59], v[240:243], v[250:253], v[56:59]
    ds_read_b128 v[160:163], v24 offset:32768
    ds_read_b64_tr_b16 v[80:81], v11 offset:16384
    ds_read_b64_tr_b16 v[82:83], v11 offset:16640
    ds_read_b128 v[164:167], v25 offset:32768
    v_mfma_f32_32x32x16_bf16 v[64:79], v[100:103], v[148:151], v[64:79]
    ds_read_b64_tr_b16 v[84:85], v11 offset:17408
    ds_read_b64_tr_b16 v[86:87], v11 offset:17664
    ds_read_b128 v[168:171], v26 offset:32768
    v_mfma_f32_32x32x16_bf16 v[64:79], v[104:107], v[152:155], v[64:79]
    s_add_u32 m0, s54, 73728
    s_add_u32 s64, s64, 57344
    buffer_load_dwordx4 v31, s[8:11], s64 offen lds
    ds_read_b64_tr_b16 v[88:89], v11 offset:18432
    ds_read_b64_tr_b16 v[90:91], v11 offset:18688
    ds_read_b128 v[172:175], v27 offset:32768
    ds_read_b64_tr_b16 v[92:93], v11 offset:19456
    v_mfma_f32_32x32x16_bf16 v[64:79], v[108:111], v[156:159], v[64:79]
    ds_read_b64_tr_b16 v[94:95], v11 offset:19712
    ds_read_b64_tr_b16 v[250:251], v14 offset:16384
    ds_read_b64_tr_b16 v[252:253], v14 offset:16640
    v_dot2c_f32_bf16 v28, s70, v152
    v_dot2c_f32_bf16 v29, v152, v152
    s_add_u32 m0, s54, 147456
    s_bfe_u32 s64, s53, 0x00040010
    s_mul_i32 s64, s64, 172032
    s_add_u32 s64, s64, 1792
    buffer_load_dwordx4 v8, s[12:15], s64 offen lds
    v_dot2c_f32_bf16 v28, s70, v153
    v_dot2c_f32_bf16 v29, v153, v153
    v_dot2c_f32_bf16 v28, s70, v154
    v_dot2c_f32_bf16 v29, v154, v154
    v_dot2c_f32_bf16 v28, s70, v155
    v_dot2c_f32_bf16 v29, v155, v155
    v_dot2c_f32_bf16 v28, s70, v156
    v_dot2c_f32_bf16 v29, v156, v156
    v_dot2c_f32_bf16 v28, s70, v157
    v_dot2c_f32_bf16 v29, v157, v157
    v_dot2c_f32_bf16 v28, s70, v158
    v_dot2c_f32_bf16 v29, v158, v158
    v_dot2c_f32_bf16 v28, s70, v159
    v_dot2c_f32_bf16 v29, v159, v159
    s_waitcnt lgkmcnt(0)
    s_waitcnt vmcnt(3)
    s_barrier
    v_mfma_f32_32x32x16_bf16 v[64:79], v[80:83], v[160:163], v[64:79]
    s_add_u32 m0, s54, 81920
    s_bfe_u32 s64, s53, 0x00040014
    s_lshl_b32 s64, s64, 7
    buffer_load_dwordx4 v31, s[8:11], s64 offen lds
    v_mfma_f32_16x16x32_bf16 v[56:59], v[240:243], v[250:253], v[56:59]
    ds_read_b128 v[176:179], v24 offset:49152
    ds_read_b64_tr_b16 v[96:97], v11 offset:24576
    ds_read_b64_tr_b16 v[98:99], v11 offset:24832
    ds_read_b128 v[180:183], v25 offset:49152
    v_mfma_f32_32x32x16_bf16 v[64:79], v[84:87], v[164:167], v[64:79]
    ds_read_b64_tr_b16 v[100:101], v11 offset:25600
    ds_read_b64_tr_b16 v[102:103], v11 offset:25856
    ds_read_b128 v[184:187], v26 offset:49152
    v_mfma_f32_32x32x16_bf16 v[64:79], v[88:91], v[168:171], v[64:79]
    s_add_u32 m0, s54, 90112
    s_add_u32 s64, s64, 57344
    buffer_load_dwordx4 v31, s[8:11], s64 offen lds
    ds_read_b64_tr_b16 v[104:105], v11 offset:26624
    ds_read_b64_tr_b16 v[106:107], v11 offset:26880
    ds_read_b128 v[188:191], v27 offset:49152
    ds_read_b64_tr_b16 v[108:109], v11 offset:27648
    v_mfma_f32_32x32x16_bf16 v[64:79], v[92:95], v[172:175], v[64:79]
    ds_read_b64_tr_b16 v[110:111], v11 offset:27904
    ds_read_b64_tr_b16 v[250:251], v14 offset:24576
    ds_read_b64_tr_b16 v[252:253], v14 offset:24832
    v_dot2c_f32_bf16 v28, s70, v168
    v_dot2c_f32_bf16 v29, v168, v168
    s_add_u32 m0, s54, 0
    s_bfe_u32 s64, s53, 0x00040014
    s_mul_i32 s64, s64, 172032
    s_add_u32 s64, s64, 1792
    buffer_load_dwordx4 v8, s[12:15], s64 offen lds
    v_dot2c_f32_bf16 v28, s70, v169
    v_dot2c_f32_bf16 v29, v169, v169
    v_dot2c_f32_bf16 v28, s70, v170
    v_dot2c_f32_bf16 v29, v170, v170
    v_dot2c_f32_bf16 v28, s70, v171
    v_dot2c_f32_bf16 v29, v171, v171
    v_dot2c_f32_bf16 v28, s70, v172
    v_dot2c_f32_bf16 v29, v172, v172
    v_dot2c_f32_bf16 v28, s70, v173
    v_dot2c_f32_bf16 v29, v173, v173
    v_dot2c_f32_bf16 v28, s70, v174
    v_dot2c_f32_bf16 v29, v174, v174
    v_dot2c_f32_bf16 v28, s70, v175
    v_dot2c_f32_bf16 v29, v175, v175
    s_waitcnt lgkmcnt(0)
    s_waitcnt vmcnt(3)
    s_barrier
    v_mfma_f32_32x32x16_bf16 v[64:79], v[96:99], v[176:179], v[64:79]
    v_mfma_f32_16x16x32_bf16 v[56:59], v[240:243], v[250:253], v[56:59]
    s_add_u32 m0, s54, 98304
    s_bfe_u32 s64, s53, 0x00040018
    s_lshl_b32 s64, s64, 7
    buffer_load_dwordx4 v31, s[8:11], s64 offen lds
    v_add_u32 v24, 0x10000, v24
    v_add_u32 v25, 0x10000, v25
    v_add_u32 v26, 0x10000, v26
    v_add_u32 v27, 0x10000, v27
    ds_read_b128 v[192:195], v24 offset:0
    v_mfma_f32_32x32x16_bf16 v[64:79], v[100:103], v[180:183], v[64:79]
    ds_read_b64_tr_b16 v[80:81], v11 offset:32768
    ds_read_b64_tr_b16 v[82:83], v11 offset:33024
    ds_read_b128 v[196:199], v25 offset:0
    ds_read_b64_tr_b16 v[84:85], v11 offset:33792
    v_mfma_f32_32x32x16_bf16 v[64:79], v[104:107], v[184:187], v[64:79]
    s_add_u32 m0, s54, 106496
    s_add_u32 s64, s64, 57344
    buffer_load_dwordx4 v31, s[8:11], s64 offen lds
    ds_read_b64_tr_b16 v[86:87], v11 offset:34048
    ds_read_b128 v[200:203], v26 offset:0
    ds_read_b64_tr_b16 v[88:89], v11 offset:34816
    ds_read_b64_tr_b16 v[90:91], v11 offset:35072
    ds_read_b128 v[204:207], v27 offset:0
    v_mfma_f32_32x32x16_bf16 v[64:79], v[108:111], v[188:191], v[64:79]
    ds_read_b64_tr_b16 v[92:93], v11 offset:35840
    ds_read_b64_tr_b16 v[94:95], v11 offset:36096
    ds_read_b64_tr_b16 v[250:251], v14 offset:32768
    ds_read_b64_tr_b16 v[252:253], v14 offset:33024
    v_dot2c_f32_bf16 v28, s70, v184
    s_add_u32 m0, s54, 8192
    s_bfe_u32 s64, s53, 0x00040018
    s_mul_i32 s64, s64, 172032
    s_add_u32 s64, s64, 1792
    buffer_load_dwordx4 v8, s[12:15], s64 offen lds
    v_dot2c_f32_bf16 v29, v184, v184
    v_dot2c_f32_bf16 v28, s70, v185
    v_dot2c_f32_bf16 v29, v185, v185
    v_dot2c_f32_bf16 v28, s70, v186
    v_dot2c_f32_bf16 v29, v186, v186
    v_dot2c_f32_bf16 v28, s70, v187
    v_dot2c_f32_bf16 v29, v187, v187
    v_dot2c_f32_bf16 v28, s70, v188
    v_dot2c_f32_bf16 v29, v188, v188
    v_dot2c_f32_bf16 v28, s70, v189
    v_dot2c_f32_bf16 v29, v189, v189
    v_dot2c_f32_bf16 v28, s70, v190
    v_dot2c_f32_bf16 v29, v190, v190
    v_dot2c_f32_bf16 v28, s70, v191
    v_dot2c_f32_bf16 v29, v191, v191
    s_waitcnt lgkmcnt(0)
    s_waitcnt vmcnt(3)
    s_barrier
    v_mfma_f32_32x32x16_bf16 v[64:79], v[80:83], v[192:195], v[64:79]
    v_mfma_f32_16x16x32_bf16 v[56:59], v[240:243], v[250:253], v[56:59]
    s_add_u32 m0, s55, 20480
    s_bfe_u32 s64, s53, 0x00040000
    s_mul_i32 s64, s64, 229376
    buffer_load_dwordx4 v9, s[44:47], s64 offen lds
    v_add_u32 v11, 0xfffe4000, v11
    ds_read_b128 v[208:211], v24 offset:16384
    ds_read_b64_tr_b16 v[96:97], v11 offset:0
    ds_read_b64_tr_b16 v[98:99], v11 offset:256
    v_mfma_f32_32x32x16_bf16 v[64:79], v[84:87], v[196:199], v[64:79]
    ds_read_b128 v[212:215], v25 offset:16384
    ds_read_b64_tr_b16 v[100:101], v11 offset:1024
    ds_read_b64_tr_b16 v[102:103], v11 offset:1280
    ds_read_b128 v[216:219], v26 offset:16384
    v_mfma_f32_32x32x16_bf16 v[64:79], v[88:91], v[200:203], v[64:79]
    s_add_u32 m0, s55, 21504
    s_nop 0
    buffer_load_dwordx4 v10, s[44:47], s64 offen lds
    ds_read_b64_tr_b16 v[104:105], v11 offset:2048
    ds_read_b64_tr_b16 v[106:107], v11 offset:2304
    ds_read_b128 v[220:223], v27 offset:16384
    ds_read_b64_tr_b16 v[108:109], v11 offset:3072
    v_mfma_f32_32x32x16_bf16 v[64:79], v[92:95], v[204:207], v[64:79]
    ds_read_b64_tr_b16 v[110:111], v11 offset:3328
    v_add_u32 v14, 0xfffe4000, v14
    ds_read_b64_tr_b16 v[250:251], v14 offset:0
    ds_read_b64_tr_b16 v[252:253], v14 offset:256
    v_dot2c_f32_bf16 v28, s70, v200
    v_dot2c_f32_bf16 v29, v200, v200
    buffer_load_dwordx2 v[44:45], off, s[32:35], 0 sc1
    s_add_u32 s67, s73, 147456
    buffer_load_dword v42, off, s[32:35], s67
    s_mul_i32 s67, s76, 28672
    buffer_load_dword v42, off, s[36:39], s67
    v_dot2c_f32_bf16 v28, s70, v201
    v_dot2c_f32_bf16 v29, v201, v201
    v_dot2c_f32_bf16 v28, s70, v202
    v_dot2c_f32_bf16 v29, v202, v202
    v_dot2c_f32_bf16 v28, s70, v203
    v_dot2c_f32_bf16 v29, v203, v203
    v_dot2c_f32_bf16 v28, s70, v204
    v_dot2c_f32_bf16 v29, v204, v204
    v_dot2c_f32_bf16 v28, s70, v205
    v_dot2c_f32_bf16 v29, v205, v205
    v_dot2c_f32_bf16 v28, s70, v206
    v_dot2c_f32_bf16 v29, v206, v206
    v_dot2c_f32_bf16 v28, s70, v207
    v_dot2c_f32_bf16 v29, v207, v207
    s_waitcnt lgkmcnt(0)
    s_waitcnt vmcnt(5)
    s_barrier
    v_mfma_f32_32x32x16_bf16 v[64:79], v[96:99], v[208:211], v[64:79]
    s_add_u32 m0, s55, 36864
    s_bfe_u32 s64, s53, 0x00040004
    s_mul_i32 s64, s64, 229376
    buffer_load_dwordx4 v9, s[44:47], s64 offen lds
    v_mfma_f32_16x16x32_bf16 v[56:59], v[240:243], v[250:253], v[56:59]
    ds_read_b128 v[224:227], v24 offset:32768
    ds_read_b64_tr_b16 v[80:81], v11 offset:8192
    ds_read_b64_tr_b16 v[82:83], v11 offset:8448
    ds_read_b128 v[228:231], v25 offset:32768
    v_mfma_f32_32x32x16_bf16 v[64:79], v[100:103], v[212:215], v[64:79]
    ds_read_b64_tr_b16 v[84:85], v11 offset:9216
    ds_read_b64_tr_b16 v[86:87], v11 offset:9472
    ds_read_b128 v[232:235], v26 offset:32768
    v_mfma_f32_32x32x16_bf16 v[64:79], v[104:107], v[216:219], v[64:79]
    ds_read_b64_tr_b16 v[88:89], v11 offset:10240
    ds_read_b64_tr_b16 v[90:91], v11 offset:10496
    ds_read_b128 v[236:239], v27 offset:32768
    ds_read_b64_tr_b16 v[92:93], v11 offset:11264
    v_mfma_f32_32x32x16_bf16 v[64:79], v[108:111], v[220:223], v[64:79]
    s_add_u32 m0, s55, 37888
    s_nop 0
    buffer_load_dwordx4 v10, s[44:47], s64 offen lds
    ds_read_b64_tr_b16 v[94:95], v11 offset:11520
    ds_read_b64_tr_b16 v[250:251], v14 offset:8192
    ds_read_b64_tr_b16 v[252:253], v14 offset:8448
    v_dot2c_f32_bf16 v28, s70, v216
    v_dot2c_f32_bf16 v29, v216, v216
    v_dot2c_f32_bf16 v28, s70, v217
    v_dot2c_f32_bf16 v29, v217, v217
    v_dot2c_f32_bf16 v28, s70, v218
    v_dot2c_f32_bf16 v29, v218, v218
    v_dot2c_f32_bf16 v28, s70, v219
    v_dot2c_f32_bf16 v29, v219, v219
    v_dot2c_f32_bf16 v28, s70, v220
    v_dot2c_f32_bf16 v29, v220, v220
    v_dot2c_f32_bf16 v28, s70, v221
    v_dot2c_f32_bf16 v29, v221, v221
    v_dot2c_f32_bf16 v28, s70, v222
    v_dot2c_f32_bf16 v29, v222, v222
    v_dot2c_f32_bf16 v28, s70, v223
    v_dot2c_f32_bf16 v29, v223, v223
    s_waitcnt lgkmcnt(0)
    s_waitcnt vmcnt(5)
    s_barrier
    v_mfma_f32_32x32x16_bf16 v[64:79], v[80:83], v[224:227], v[64:79]
    s_add_u32 m0, s55, 53248
    s_bfe_u32 s64, s53, 0x00040008
    s_mul_i32 s64, s64, 229376
    buffer_load_dwordx4 v9, s[44:47], s64 offen lds
    v_mfma_f32_16x16x32_bf16 v[56:59], v[240:243], v[250:253], v[56:59]
    v_mfma_f32_32x32x16_bf16 v[64:79], v[84:87], v[228:231], v[64:79]
    v_mfma_f32_32x32x16_bf16 v[64:79], v[88:91], v[232:235], v[64:79]
    v_mfma_f32_32x32x16_bf16 v[64:79], v[92:95], v[236:239], v[64:79]
    s_add_u32 m0, s55, 54272
    s_nop 0
    buffer_load_dwordx4 v10, s[44:47], s64 offen lds
    ds_read_b64_tr_b16 v[112:113], v12 offset:32
    ds_read_b64_tr_b16 v[114:115], v13 offset:32
    ds_read_b64_tr_b16 v[116:117], v12 offset:64
    ds_read_b64_tr_b16 v[118:119], v13 offset:64
    ds_read_b64_tr_b16 v[120:121], v12 offset:1568
    ds_read_b64_tr_b16 v[122:123], v13 offset:1568
    v_dot2c_f32_bf16 v28, s70, v232
    v_dot2c_f32_bf16 v29, v232, v232
    v_dot2c_f32_bf16 v28, s70, v233
    v_dot2c_f32_bf16 v29, v233, v233
    v_dot2c_f32_bf16 v28, s70, v234
    v_dot2c_f32_bf16 v29, v234, v234
    v_dot2c_f32_bf16 v28, s70, v235
    s_lshl_b32 s69, s2, 2
    s_add_u32 s69, s69, s58
    v_min_u32 v34, 12, v1
    v_lshlrev_b32 v34, 7, v34
    s_mul_i32 s64, s69, 1664
    buffer_load_dword v33, v34, s[16:19], s64 offen
    v_min_u32 v34, 12, v1
    v_lshlrev_b32 v34, 7, v34
    s_mul_i32 s64, s69, 1664
    buffer_load_dword v33, v34, s[20:23], s64 offen
    v_min_u32 v34, 12, v1
    v_lshlrev_b32 v34, 7, v34
    s_mul_i32 s64, s69, 1664
    buffer_load_dword v33, v34, s[24:27], s64 offen
    v_min_u32 v34, 3, v1
    v_lshlrev_b32 v34, 7, v34
    s_mul_i32 s64, s69, 512
    buffer_load_dword v33, v34, s[28:31], s64 offen
    v_dot2c_f32_bf16 v29, v235, v235
    v_dot2c_f32_bf16 v28, s70, v236
    v_dot2c_f32_bf16 v29, v236, v236
    v_dot2c_f32_bf16 v28, s70, v237
    v_dot2c_f32_bf16 v29, v237, v237
    v_dot2c_f32_bf16 v28, s70, v238
    v_dot2c_f32_bf16 v29, v238, v238
    v_dot2c_f32_bf16 v28, s70, v239
    v_dot2c_f32_bf16 v29, v239, v239
    s_waitcnt lgkmcnt(4)
    v_mfma_f32_32x32x16_bf16 v[80:95], v[112:115], v[128:131], 0
    ds_read_b64_tr_b16 v[124:125], v12 offset:1600
    ds_read_b64_tr_b16 v[126:127], v13 offset:1600
    v_lshrrev_b32 v30, 1, v2
    s_lshr_b32 s65, s54, 1
    s_add_u32 s65, s65, 159744
    v_add_u32 v30, s65, v30
    s_mov_b32 s83, 0x07060302
    v_and_b32 v255, 31, v1
    v_lshlrev_b32 v255, 4, v255
    v_add_u32 v255, 158720, v255
    s_lshl_b32 s65, s58, 2
    v_add_u32 v254, s65, v255
    ds_write_b64 v30, v[28:29]
    ds_write_b32 v254, v56
    v_xor_b32 v30, 2048, v30
    s_waitcnt vmcnt(10)
    v_readfirstlane_b32 s56, v44
    v_readfirstlane_b32 s57, v45
    s_nop 0
    s_add_u32 s56, s56, 0x9e3779b9
    s_add_u32 s57, s57, 0x7f4a7c15
    s_waitcnt vmcnt(8)
    v_mov_b32 v42, 0
    s_waitcnt lgkmcnt(6)
    v_mfma_f32_32x32x16_bf16 v[96:111], v[116:119], v[128:131], 0
    ds_read_b64_tr_b16 v[112:113], v12 offset:3104
    ds_read_b64_tr_b16 v[114:115], v13 offset:3104
    ds_read_b64_tr_b16 v[250:251], v15 offset:32
    ds_read_b64_tr_b16 v[252:253], v16 offset:32
    s_waitcnt lgkmcnt(8)
    v_mfma_f32_32x32x16_bf16 v[80:95], v[120:123], v[132:135], v[80:95]
    ds_read_b64_tr_b16 v[116:117], v12 offset:3136
    ds_read_b64_tr_b16 v[118:119], v13 offset:3136
    s_waitcnt lgkmcnt(8)
    v_mfma_f32_32x32x16_bf16 v[96:111], v[124:127], v[132:135], v[96:111]
    s_waitcnt lgkmcnt(2)
    v_mfma_f32_16x16x32_bf16 v[56:59], v[240:243], v[250:253], 0
    ds_read_b64_tr_b16 v[120:121], v12 offset:4640
    ds_read_b64_tr_b16 v[122:123], v13 offset:4640
    ds_read_b64_tr_b16 v[250:251], v15 offset:64
    ds_read_b64_tr_b16 v[252:253], v16 offset:64
    v_mfma_f32_32x32x16_bf16 v[80:95], v[112:115], v[136:139], v[80:95]
    ds_read_b64_tr_b16 v[124:125], v12 offset:4672
    ds_read_b64_tr_b16 v[126:127], v13 offset:4672
    s_waitcnt vmcnt(6)
    s_barrier
    s_waitcnt lgkmcnt(6)
    v_mfma_f32_32x32x16_bf16 v[96:111], v[116:119], v[136:139], v[96:111]
    s_waitcnt lgkmcnt(2)
    v_mfma_f32_16x16x32_bf16 v[60:63], v[240:243], v[250:253], 0
    ds_read_b64_tr_b16 v[112:113], v12 offset:16416
    ds_read_b64_tr_b16 v[114:115], v13 offset:16416
    ds_read_b64 v[30:31], v30
    v_mfma_f32_32x32x16_bf16 v[80:95], v[120:123], v[140:143], v[80:95]
    ds_read_b64_tr_b16 v[116:117], v12 offset:16448
    ds_read_b64_tr_b16 v[118:119], v13 offset:16448
    s_add_u32 m0, s90, 65536
    s_bfe_u32 s64, s53, 0x0004000c
    s_mul_i32 s64, s64, 172032
    buffer_load_dwordx4 v8, s[12:15], s64 offen lds
    s_waitcnt lgkmcnt(5)
    v_mfma_f32_32x32x16_bf16 v[96:111], v[124:127], v[140:143], v[96:111]
    ds_read_b64_tr_b16 v[120:121], v12 offset:17952
    ds_read_b64_tr_b16 v[122:123], v13 offset:17952
    s_waitcnt lgkmcnt(4)
    v_add_f32 v28, v28, v30
    v_add_f32 v29, v29, v31
    s_nop 1
    v_permlane32_swap_b32 v28, v29
    v_add_f32 v28, v28, v29
    v_mul_f32 v28, 0x3b124925, v28
    v_mov_b32 v29, v28
    s_nop 1
    v_permlane32_swap_b32 v28, v29
    s_add_u32 m0, s90, 69632
    s_bfe_u32 s64, s53, 0x0004000c
    s_mul_i32 s64, s64, 229376
    buffer_load_dwordx4 v22, s[16:19], s64 offen lds
    v_mfma_f32_32x32x16_bf16 v[80:95], v[112:115], v[144:147], v[80:95]
    ds_read_b64_tr_b16 v[124:125], v12 offset:17984
    ds_read_b64_tr_b16 v[126:127], v13 offset:17984
    v_fma_f32 v29, -v28, v28, v29
    v_max_f32 v29, 0, v29
    v_sub_f32 v28, 0, v28
    v_cvt_pk_bf16_f32 v30, v28, v29
    v_and_b32 v29, 0xffff0000, v30
    v_add_f32 v29, 0x3727c5ac, v29
    v_and_b32 v30, 0xffff, v30
    v_cvt_pk_bf16_f32 v29, v29, v29
    s_waitcnt lgkmcnt(4)
    v_mfma_f32_32x32x16_bf16 v[96:111], v[116:119], v[144:147], v[96:111]
    ds_read_b64_tr_b16 v[112:113], v12 offset:19488
    ds_read_b64_tr_b16 v[114:115], v13 offset:19488
    v_cmp_gt_u32 vcc, 32, v1
    v_and_b32 v29, 0xffff0000, v29
    v_sqrt_f32 v29, v29
    v_cndmask_b32 v247, 0, v30, vcc
    v_cvt_pk_bf16_f32 v29, v29, v29
    v_lshl_or_b32 v246, v247, 16, v247
    v_and_b32 v29, 0xffff0000, v29
    ds_read_b128 v[250:253], v255 offset:0
    s_add_u32 m0, s55, 69632
    s_nop 0
    buffer_load_dwordx4 v9, s[44:47], s64 offen lds
    s_waitcnt lgkmcnt(5)
    v_mfma_f32_32x32x16_bf16 v[80:95], v[120:123], v[148:151], v[80:95]
    ds_read_b64_tr_b16 v[116:117], v12 offset:19520
    ds_read_b64_tr_b16 v[118:119], v13 offset:19520
    v_rcp_f32 v28, v29
    v_mul_f32 v4, v29, v29
    v_mov_b32 v5, v29
    v_mul_f32 v6, 0xc0135761, v28
    v_mul_f32 v30, v28, v28
    v_mul_f32 v7, 0x3d372713, v6
    v_mul_f32 v7, v7, v30
    s_add_u32 m0, s55, 70656
    s_nop 0
    buffer_load_dwordx4 v10, s[44:47], s64 offen lds
    s_waitcnt lgkmcnt(5)
    v_mfma_f32_32x32x16_bf16 v[96:111], v[124:127], v[148:151], v[96:111]
    ds_read_b64_tr_b16 v[120:121], v12 offset:21024
    ds_read_b64_tr_b16 v[122:123], v13 offset:21024
    s_waitcnt lgkmcnt(4)
    v_add_f32 v250, v250, v251
    v_add_f32 v252, v252, v253
    v_add_f32 v250, v250, v252
    v_and_b32 v251, 0xffff0000, v250
    v_sub_f32 v251, v250, v251
    v_and_b32 v252, 0xffff0000, v251
    v_perm_b32 v244, v251, v250, s83
    v_sub_f32 v252, v251, v252
    v_lshrrev_b32 v245, 16, v252
    v_mfma_f32_32x32x16_bf16 v[80:95], v[112:115], v[152:155], v[80:95]
    s_waitcnt vmcnt(8)
    s_barrier
    v_mfma_f32_32x32x16_bf16 v[64:79], v[244:247], v[246:249], v[64:79]
    ds_read_b64_tr_b16 v[124:125], v12 offset:21056
    ds_read_b64_tr_b16 v[126:127], v13 offset:21056
    ds_read_b64_tr_b16 v[250:251], v15 offset:16416
    ds_read_b64_tr_b16 v[252:253], v16 offset:16416
    v_bfe_u32 v24, v1, 2, 2
    v_lshrrev_b32 v25, 4, v1
    v_lshl_add_u32 v24, v25, 3, v24
    s_waitcnt lgkmcnt(6)
    v_mfma_f32_32x32x16_bf16 v[96:111], v[116:119], v[152:155], v[96:111]
    ds_read_b64_tr_b16 v[112:113], v12 offset:32800
    ds_read_b64_tr_b16 v[114:115], v13 offset:32800
    v_and_b32 v25, 3, v1
    v_and_b32 v26, 9, v24
    s_waitcnt lgkmcnt(6)
    v_mfma_f32_32x32x16_bf16 v[80:95], v[120:123], v[156:159], v[80:95]
    s_waitcnt lgkmcnt(2)
    v_mfma_f32_16x16x32_bf16 v[56:59], v[240:243], v[250:253], v[56:59]
    ds_read_b64_tr_b16 v[116:117], v12 offset:32832
    ds_read_b64_tr_b16 v[118:119], v13 offset:32832
    ds_read_b64_tr_b16 v[250:251], v15 offset:16448
    ds_read_b64_tr_b16 v[252:253], v16 offset:16448
    v_bfe_u32 v27, v24, 1, 1
    v_lshl_or_b32 v26, v27, 2, v26
    s_lshl_b32 s66, s58, 2
    v_or_b32 v27, s66, v25
    s_add_u32 m0, s90, 81920
    s_bfe_u32 s64, s53, 0x00040010
    s_mul_i32 s64, s64, 172032
    buffer_load_dwordx4 v8, s[12:15], s64 offen lds
    v_mfma_f32_32x32x16_bf16 v[96:111], v[124:127], v[156:159], v[96:111]
    ds_read_b64_tr_b16 v[120:121], v12 offset:34336
    ds_read_b64_tr_b16 v[122:123], v13 offset:34336
    v_xor_b32 v26, v26, v27
    v_lshlrev_b32 v27, 7, v24
    s_add_u32 m0, s90, 86016
    s_bfe_u32 s64, s53, 0x00040010
    s_mul_i32 s64, s64, 229376
    buffer_load_dwordx4 v22, s[16:19], s64 offen lds
    s_waitcnt lgkmcnt(6)
    v_mfma_f32_32x32x16_bf16 v[80:95], v[112:115], v[160:163], v[80:95]
    s_waitcnt lgkmcnt(2)
    v_mfma_f32_16x16x32_bf16 v[60:63], v[240:243], v[250:253], v[60:63]
    ds_read_b64_tr_b16 v[124:125], v12 offset:34368
    ds_read_b64_tr_b16 v[126:127], v13 offset:34368
    ds_read_b64_tr_b16 v[250:251], v15 offset:32800
    ds_read_b64_tr_b16 v[252:253], v16 offset:32800
    v_add_u32 v27, 139264, v27
    v_lshl_add_u32 v28, v26, 3, v27
    v_mfma_f32_32x32x16_bf16 v[96:111], v[116:119], v[160:163], v[96:111]
    ds_read_b64_tr_b16 v[112:113], v12 offset:35872
    ds_read_b64_tr_b16 v[114:115], v13 offset:35872
    v_bfe_u32 v26, v24, 1, 3
    v_xor_b32 v26, v26, v25
    v_lshlrev_b32 v27, 6, v24
    s_add_u32 m0, s55, 86016
    s_nop 0
    buffer_load_dwordx4 v9, s[44:47], s64 offen lds
    s_waitcnt lgkmcnt(6)
    v_mfma_f32_32x32x16_bf16 v[80:95], v[120:123], v[164:167], v[80:95]
    s_waitcnt lgkmcnt(2)
    v_mfma_f32_16x16x32_bf16 v[56:59], v[240:243], v[250:253], v[56:59]
    ds_read_b64_tr_b16 v[116:117], v12 offset:35904
    ds_read_b64_tr_b16 v[118:119], v13 offset:35904
    ds_read_b64_tr_b16 v[250:251], v15 offset:32832
    ds_read_b64_tr_b16 v[252:253], v16 offset:32832
    v_add_u32 v27, 131072, v27
    v_lshl_add_u32 v29, v26, 3, v27
    s_add_u32 m0, s55, 87040
    s_nop 0
    buffer_load_dwordx4 v10, s[44:47], s64 offen lds
    v_mfma_f32_32x32x16_bf16 v[96:111], v[124:127], v[164:167], v[96:111]
    ds_read_b64_tr_b16 v[120:121], v12 offset:37408
    ds_read_b64_tr_b16 v[122:123], v13 offset:37408
    v_bfe_u32 v24, v1, 4, 1
    v_and_b32 v25, 15, v1
    s_waitcnt lgkmcnt(6)
    v_mfma_f32_32x32x16_bf16 v[80:95], v[112:115], v[168:171], v[80:95]
    s_waitcnt vmcnt(4)
    s_barrier
    s_waitcnt lgkmcnt(2)
    v_mfma_f32_16x16x32_bf16 v[60:63], v[240:243], v[250:253], v[60:63]
    ds_read_b64_tr_b16 v[124:125], v12 offset:37440
    ds_read_b64_tr_b16 v[126:127], v13 offset:37440
    v_lshl_or_b32 v24, v24, 5, v25
    v_lshrrev_b32 v25, 5, v1
    v_lshlrev_b32 v26, 3, v25
    v_mfma_f32_32x32x16_bf16 v[96:111], v[116:119], v[168:171], v[96:111]
    ds_read_b64_tr_b16 v[112:113], v12 offset:49184
    ds_read_b64_tr_b16 v[114:115], v13 offset:49184
    ds_read_b64_tr_b16 v[250:251], v15 offset:49184
    ds_read_b64_tr_b16 v[252:253], v16 offset:49184
    v_lshl_or_b32 v23, v24, 4, v26
    s_lshl_b32 s68, s50, 4
    s_add_u32 s68, s68, s49
    s_lshl_b32 s68, s68, 2
    s_waitcnt lgkmcnt(6)
    v_mfma_f32_32x32x16_bf16 v[80:95], v[120:123], v[172:175], v[80:95]
    ds_read_b64_tr_b16 v[116:117], v12 offset:49216
    ds_read_b64_tr_b16 v[118:119], v13 offset:49216
    s_add_u32 s68, s68, s58
    s_lshl_b32 s68, s68, 10
    s_add_u32 s68, s68, 262144
    s_lshl_b32 s69, s49, 3
    s_add_u32 s69, s69, s82
    v_and_b32 v24, 31, v1
    s_lshl_b32 s66, s58, 5
    v_add_u32 v24, s66, v24
    s_add_u32 m0, s90, 98304
    s_bfe_u32 s64, s53, 0x00040014
    s_mul_i32 s64, s64, 172032
    buffer_load_dwordx4 v8, s[12:15], s64 offen lds
    s_add_u32 m0, s90, 102400
    s_bfe_u32 s64, s53, 0x00040014
    s_mul_i32 s64, s64, 229376
    buffer_load_dwordx4 v22, s[16:19], s64 offen lds
    s_waitcnt lgkmcnt(6)
    v_mfma_f32_32x32x16_bf16 v[96:111], v[124:127], v[172:175], v[96:111]
    s_waitcnt lgkmcnt(2)
    v_mfma_f32_16x16x32_bf16 v[56:59], v[240:243], v[250:253], v[56:59]
    ds_read_b64_tr_b16 v[120:121], v12 offset:50720
    ds_read_b64_tr_b16 v[122:123], v13 offset:50720
    ds_read_b64_tr_b16 v[250:251], v15 offset:49216
    ds_read_b64_tr_b16 v[252:253], v16 offset:49216
    v_bfe_u32 v26, v1, 1, 3
    v_xor_b32 v26, v26, v25
    s_add_u32 m0, s55, 102400
    s_nop 0
    buffer_load_dwordx4 v9, s[44:47], s64 offen lds
    v_mfma_f32_32x32x16_bf16 v[80:95], v[112:115], v[176:179], v[80:95]
    ds_read_b64_tr_b16 v[124:125], v12 offset:50752
    ds_read_b64_tr_b16 v[126:127], v13 offset:50752
    v_lshlrev_b32 v27, 6, v24
    v_add_u32 v27, 131072, v27
    s_add_u32 m0, s55, 103424
    s_nop 0
    buffer_load_dwordx4 v10, s[44:47], s64 offen lds
    s_waitcnt lgkmcnt(6)
    v_mfma_f32_32x32x16_bf16 v[96:111], v[116:119], v[176:179], v[96:111]
    s_waitcnt lgkmcnt(2)
    v_mfma_f32_16x16x32_bf16 v[60:63], v[240:243], v[250:253], v[60:63]
    ds_read_b64_tr_b16 v[112:113], v12 offset:52256
    ds_read_b64_tr_b16 v[114:115], v13 offset:52256
    v_cmp_lt_u32 vcc, 31, v1
    s_nop 1
    v_cndmask_b32 v76, v5, v76, vcc
    v_cvt_pk_bf16_f32 v64, v64, v65
    s_add_u32 m0, s90, 0
    s_bfe_u32 s64, s53, 0x00040000
    s_mul_i32 s64, s64, 229376
    buffer_load_dwordx4 v17, s[16:19], s64 offen lds
    s_add_u32 m0, s90, 8192
    s_nop 0
    buffer_load_dwordx4 v18, s[20:23], s64 offen lds
    v_mfma_f32_32x32x16_bf16 v[80:95], v[120:123], v[180:183], v[80:95]
    ds_read_b64_tr_b16 v[116:117], v12 offset:52288
    ds_read_b64_tr_b16 v[118:119], v13 offset:52288
    v_cvt_pk_bf16_f32 v65, v66, v67
    v_cvt_pk_bf16_f32 v66, v68, v69
    s_add_u32 m0, s90, 4096
    s_add_u32 s64, s64, 114688
    buffer_load_dwordx4 v17, s[16:19], s64 offen lds
    s_waitcnt lgkmcnt(4)
    v_mfma_f32_32x32x16_bf16 v[96:111], v[124:127], v[180:183], v[96:111]
    ds_read_b64_tr_b16 v[120:121], v12 offset:53792
    ds_read_b64_tr_b16 v[122:123], v13 offset:53792
    v_cvt_pk_bf16_f32 v67, v70, v71
    v_cvt_pk_bf16_f32 v68, v72, v73
    s_add_u32 m0, s90, 12288
    s_nop 0
    buffer_load_dwordx4 v18, s[20:23], s64 offen lds
    s_waitcnt lgkmcnt(4)
    v_mfma_f32_32x32x16_bf16 v[80:95], v[112:115], v[184:187], v[80:95]
    s_waitcnt vmcnt(8)
    s_barrier
    ds_read_b64_tr_b16 v[124:125], v12 offset:53824
    ds_read_b64_tr_b16 v[126:127], v13 offset:53824
    v_cvt_pk_bf16_f32 v69, v74, v75
    v_cvt_pk_bf16_f32 v70, v76, v77
    v_cvt_pk_bf16_f32 v71, v78, v79
    s_waitcnt lgkmcnt(4)
    v_mfma_f32_32x32x16_bf16 v[96:111], v[116:119], v[184:187], v[96:111]
    v_add_u32 v12, 0x00010000, v12
    v_add_u32 v13, 0x00010000, v13
    ds_read_b64_tr_b16 v[112:113], v12 offset:32
    ds_read_b64_tr_b16 v[114:115], v13 offset:32
    v_add_u32 v15, 0x00010000, v15
    v_add_u32 v16, 0x00010000, v16
    ds_read_b64_tr_b16 v[250:251], v15 offset:32
    ds_read_b64_tr_b16 v[252:253], v16 offset:32
    v_xor_b32 v24, 0, v26
    v_lshl_add_u32 v24, v24, 3, v27
    s_waitcnt lgkmcnt(6)
    v_mfma_f32_32x32x16_bf16 v[80:95], v[120:123], v[188:191], v[80:95]
    ds_read_b64_tr_b16 v[116:117], v12 offset:64
    ds_read_b64_tr_b16 v[118:119], v13 offset:64
    ds_write_b64 v24, v[64:65]
    v_xor_b32 v24, 2, v26
    v_lshl_add_u32 v24, v24, 3, v27
    s_add_u32 m0, s90, 114688
    s_bfe_u32 s64, s53, 0x00040018
    s_mul_i32 s64, s64, 172032
    buffer_load_dwordx4 v8, s[12:15], s64 offen lds
    s_add_u32 m0, s90, 118784
    s_bfe_u32 s64, s53, 0x00040018
    s_mul_i32 s64, s64, 229376
    buffer_load_dwordx4 v22, s[16:19], s64 offen lds
    s_waitcnt lgkmcnt(7)
    v_mfma_f32_32x32x16_bf16 v[96:111], v[124:127], v[188:191], v[96:111]
    s_waitcnt lgkmcnt(3)
    v_mfma_f32_16x16x32_bf16 v[56:59], v[240:243], v[250:253], v[56:59]
    ds_read_b64_tr_b16 v[120:121], v12 offset:1568
    ds_read_b64_tr_b16 v[122:123], v13 offset:1568
    ds_read_b64_tr_b16 v[250:251], v15 offset:64
    ds_read_b64_tr_b16 v[252:253], v16 offset:64
    ds_write_b64 v24, v[66:67]
    v_xor_b32 v24, 4, v26
    s_add_u32 m0, s55, 118784
    s_nop 0
    buffer_load_dwordx4 v9, s[44:47], s64 offen lds
    v_mfma_f32_32x32x16_bf16 v[80:95], v[112:115], v[192:195], v[80:95]
    ds_read_b64_tr_b16 v[124:125], v12 offset:1600
    ds_read_b64_tr_b16 v[126:127], v13 offset:1600
    v_lshl_add_u32 v24, v24, 3, v27
    ds_write_b64 v24, v[68:69]
    s_add_u32 m0, s55, 119808
    s_nop 0
    buffer_load_dwordx4 v10, s[44:47], s64 offen lds
    s_waitcnt lgkmcnt(9)
    v_mfma_f32_32x32x16_bf16 v[96:111], v[116:119], v[192:195], v[96:111]
    s_waitcnt lgkmcnt(4)
    v_mfma_f32_16x16x32_bf16 v[60:63], v[240:243], v[250:253], v[60:63]
    ds_read_b64_tr_b16 v[112:113], v12 offset:3104
    ds_read_b64_tr_b16 v[114:115], v13 offset:3104
    v_xor_b32 v24, 6, v26
    v_lshl_add_u32 v24, v24, 3, v27
    ds_write_b64 v24, v[70:71]
    s_add_u32 m0, s90, 16384
    s_bfe_u32 s64, s53, 0x00040004
    s_mul_i32 s64, s64, 229376
    buffer_load_dwordx4 v17, s[16:19], s64 offen lds
    s_add_u32 m0, s90, 24576
    s_nop 0
    buffer_load_dwordx4 v18, s[20:23], s64 offen lds
    v_mfma_f32_32x32x16_bf16 v[80:95], v[120:123], v[196:199], v[80:95]
    ds_read_b64_tr_b16 v[116:117], v12 offset:3136
    ds_read_b64_tr_b16 v[118:119], v13 offset:3136
    v_xor_b32 v72, 16, v28
    v_xor_b32 v73, 32, v29
    s_add_u32 m0, s90, 20480
    s_add_u32 s64, s64, 114688
    buffer_load_dwordx4 v17, s[16:19], s64 offen lds
    s_waitcnt lgkmcnt(6)
    v_mfma_f32_32x32x16_bf16 v[96:111], v[124:127], v[196:199], v[96:111]
    ds_read_b64_tr_b16 v[120:121], v12 offset:4640
    ds_read_b64_tr_b16 v[122:123], v13 offset:4640
    v_xor_b32 v74, 16, v29
    v_xor_b32 v75, 48, v29
    s_add_u32 m0, s90, 28672
    s_nop 0
    buffer_load_dwordx4 v18, s[20:23], s64 offen lds
    s_waitcnt lgkmcnt(5)
    v_mfma_f32_32x32x16_bf16 v[80:95], v[112:115], v[200:203], v[80:95]
    ds_read_b64_tr_b16 v[124:125], v12 offset:4672
    ds_read_b64_tr_b16 v[126:127], v13 offset:4672
    s_waitcnt lgkmcnt(6)
    s_waitcnt vmcnt(12)
    s_barrier
    s_waitcnt lgkmcnt(4)
    v_mfma_f32_32x32x16_bf16 v[96:111], v[116:119], v[200:203], v[96:111]
    ds_read_b64_tr_b16 v[112:113], v12 offset:16416
    ds_read_b64_tr_b16 v[114:115], v13 offset:16416
    ds_read_b64_tr_b16 v[250:251], v15 offset:16416
    ds_read_b64_tr_b16 v[252:253], v16 offset:16416
    ds_read_b64_tr_b16 v[32:33], v28 offset:0
    ds_read_b64_tr_b16 v[34:35], v72 offset:512
    ds_read_b64_tr_b16 v[36:37], v29 offset:0
    ds_read_b64_tr_b16 v[38:39], v74 offset:256
    ds_read_b64_tr_b16 v[40:41], v73 offset:0
    ds_read_b64_tr_b16 v[42:43], v75 offset:256
    s_waitcnt lgkmcnt(12)
    v_mfma_f32_32x32x16_bf16 v[80:95], v[120:123], v[204:207], v[80:95]
    ds_read_b64_tr_b16 v[116:117], v12 offset:16448
    ds_read_b64_tr_b16 v[118:119], v13 offset:16448
    s_add_u32 m0, s90, 32768
    s_bfe_u32 s64, s53, 0x00040008
    s_mul_i32 s64, s64, 229376
    buffer_load_dwordx4 v17, s[16:19], s64 offen lds
    s_add_u32 m0, s90, 40960
    s_nop 0
    buffer_load_dwordx4 v18, s[20:23], s64 offen lds
    s_waitcnt lgkmcnt(12)
    v_mfma_f32_32x32x16_bf16 v[96:111], v[124:127], v[204:207], v[96:111]
    s_waitcnt lgkmcnt(8)
    v_mfma_f32_16x16x32_bf16 v[56:59], v[240:243], v[250:253], v[56:59]
    ds_read_b64_tr_b16 v[120:121], v12 offset:17952
    ds_read_b64_tr_b16 v[122:123], v13 offset:17952
    ds_read_b64_tr_b16 v[250:251], v15 offset:16448
    ds_read_b64_tr_b16 v[252:253], v16 offset:16448
    s_waitcnt lgkmcnt(8)
    v_mfma_f32_16x16x32_bf16 v[44:47], v[32:35], v[36:39], 0
    s_waitcnt lgkmcnt(6)
    v_mfma_f32_16x16x32_bf16 v[48:51], v[32:35], v[40:43], 0
    ds_read_b64_tr_b16 v[32:33], v28 offset:4096
    ds_read_b64_tr_b16 v[34:35], v72 offset:4608
    ds_read_b64_tr_b16 v[36:37], v29 offset:2048
    ds_read_b64_tr_b16 v[38:39], v74 offset:2304
    ds_read_b64_tr_b16 v[40:41], v73 offset:2048
    ds_read_b64_tr_b16 v[42:43], v75 offset:2304
    s_add_u32 m0, s90, 36864
    s_add_u32 s64, s64, 114688
    buffer_load_dwordx4 v17, s[16:19], s64 offen lds
    v_mfma_f32_32x32x16_bf16 v[80:95], v[112:115], v[208:211], v[80:95]
    ds_read_b64_tr_b16 v[124:125], v12 offset:17984
    ds_read_b64_tr_b16 v[126:127], v13 offset:17984
    s_add_u32 m0, s90, 45056
    s_nop 0
    buffer_load_dwordx4 v18, s[20:23], s64 offen lds
    s_waitcnt lgkmcnt(12)
    v_mfma_f32_32x32x16_bf16 v[96:111], v[116:119], v[208:211], v[96:111]
    s_waitcnt lgkmcnt(8)
    v_mfma_f32_16x16x32_bf16 v[60:63], v[240:243], v[250:253], v[60:63]
    ds_read_b64_tr_b16 v[112:113], v12 offset:19488
    ds_read_b64_tr_b16 v[114:115], v13 offset:19488
    s_waitcnt lgkmcnt(6)
    v_mfma_f32_16x16x32_bf16 v[44:47], v[32:35], v[36:39], v[44:47]
    s_waitcnt lgkmcnt(4)
    v_mfma_f32_16x16x32_bf16 v[48:51], v[32:35], v[40:43], v[48:51]
    ds_read_b64_tr_b16 v[32:33], v28 offset:8192
    ds_read_b64_tr_b16 v[34:35], v72 offset:8704
    ds_read_b64_tr_b16 v[36:37], v29 offset:4096
    ds_read_b64_tr_b16 v[38:39], v74 offset:4352
    ds_read_b64_tr_b16 v[40:41], v73 offset:4096
    ds_read_b64_tr_b16 v[42:43], v75 offset:4352
    s_add_u32 m0, s90, 49152
    s_bfe_u32 s64, s53, 0x0004000c
    s_mul_i32 s64, s64, 229376
    buffer_load_dwordx4 v17, s[16:19], s64 offen lds
    s_add_u32 m0, s90, 57344
    s_nop 0
    buffer_load_dwordx4 v18, s[20:23], s64 offen lds
    v_mfma_f32_32x32x16_bf16 v[80:95], v[120:123], v[212:215], v[80:95]
    ds_read_b64_tr_b16 v[116:117], v12 offset:19520
    ds_read_b64_tr_b16 v[118:119], v13 offset:19520
    s_add_u32 m0, s90, 53248
    s_add_u32 s64, s64, 114688
    buffer_load_dwordx4 v17, s[16:19], s64 offen lds
    s_waitcnt lgkmcnt(10)
    v_mfma_f32_32x32x16_bf16 v[96:111], v[124:127], v[212:215], v[96:111]
    ds_read_b64_tr_b16 v[120:121], v12 offset:21024
    ds_read_b64_tr_b16 v[122:123], v13 offset:21024
    s_waitcnt lgkmcnt(6)
    v_mfma_f32_16x16x32_bf16 v[44:47], v[32:35], v[36:39], v[44:47]
    s_waitcnt lgkmcnt(4)
    v_mfma_f32_16x16x32_bf16 v[48:51], v[32:35], v[40:43], v[48:51]
    ds_read_b64_tr_b16 v[32:33], v28 offset:12288
    ds_read_b64_tr_b16 v[34:35], v72 offset:12800
    ds_read_b64_tr_b16 v[36:37], v29 offset:6144
    ds_read_b64_tr_b16 v[38:39], v74 offset:6400
    ds_read_b64_tr_b16 v[40:41], v73 offset:6144
    ds_read_b64_tr_b16 v[42:43], v75 offset:6400
    s_add_u32 m0, s90, 61440
    s_nop 0
    buffer_load_dwordx4 v18, s[20:23], s64 offen lds
    v_mfma_f32_32x32x16_bf16 v[80:95], v[112:115], v[216:219], v[80:95]
    s_waitcnt vmcnt(12)
    s_barrier
    ds_read_b64_tr_b16 v[124:125], v12 offset:21056
    ds_read_b64_tr_b16 v[126:127], v13 offset:21056
    s_waitcnt lgkmcnt(10)
    v_mfma_f32_32x32x16_bf16 v[96:111], v[116:119], v[216:219], v[96:111]
    ds_read_b64_tr_b16 v[112:113], v12 offset:32800
    ds_read_b64_tr_b16 v[114:115], v13 offset:32800
    ds_read_b64_tr_b16 v[250:251], v15 offset:32800
    ds_read_b64_tr_b16 v[252:253], v16 offset:32800
    s_waitcnt lgkmcnt(8)
    v_mfma_f32_16x16x32_bf16 v[44:47], v[32:35], v[36:39], v[44:47]
    s_waitcnt lgkmcnt(6)
    v_mfma_f32_16x16x32_bf16 v[48:51], v[32:35], v[40:43], v[48:51]
    v_mfma_f32_32x32x16_bf16 v[80:95], v[120:123], v[220:223], v[80:95]
    ds_read_b64_tr_b16 v[116:117], v12 offset:32832
    ds_read_b64_tr_b16 v[118:119], v13 offset:32832
    s_waitcnt lgkmcnt(6)
    v_mfma_f32_32x32x16_bf16 v[96:111], v[124:127], v[220:223], v[96:111]
    s_waitcnt lgkmcnt(2)
    v_mfma_f32_16x16x32_bf16 v[56:59], v[240:243], v[250:253], v[56:59]
    ds_read_b64_tr_b16 v[120:121], v12 offset:34336
    ds_read_b64_tr_b16 v[122:123], v13 offset:34336
    ds_read_b64_tr_b16 v[250:251], v15 offset:32832
    ds_read_b64_tr_b16 v[252:253], v16 offset:32832
    v_cvt_pk_bf16_f32 v24, v44, v45
    v_cvt_pk_bf16_f32 v25, v46, v47
    v_cvt_pk_bf16_f32 v26, v48, v49
    v_cvt_pk_bf16_f32 v27, v50, v51
    buffer_store_dwordx2 v[24:25], v23, s[32:35], s68 offen sc1
    buffer_store_dwordx2 v[26:27], v23, s[32:35], s68 offen offset:256 sc1
    v_mfma_f32_32x32x16_bf16 v[80:95], v[112:115], v[224:227], v[80:95]
    ds_read_b64_tr_b16 v[124:125], v12 offset:34368
    ds_read_b64_tr_b16 v[126:127], v13 offset:34368
    s_waitcnt lgkmcnt(6)
    v_mfma_f32_32x32x16_bf16 v[96:111], v[116:119], v[224:227], v[96:111]
    s_waitcnt lgkmcnt(2)
    v_mfma_f32_16x16x32_bf16 v[60:63], v[240:243], v[250:253], v[60:63]
    ds_read_b64_tr_b16 v[112:113], v12 offset:35872
    ds_read_b64_tr_b16 v[114:115], v13 offset:35872
    v_mfma_f32_32x32x16_bf16 v[80:95], v[120:123], v[228:231], v[80:95]
    ds_read_b64_tr_b16 v[116:117], v12 offset:35904
    ds_read_b64_tr_b16 v[118:119], v13 offset:35904
    s_waitcnt lgkmcnt(4)
    v_mfma_f32_32x32x16_bf16 v[96:111], v[124:127], v[228:231], v[96:111]
    ds_read_b64_tr_b16 v[120:121], v12 offset:37408
    ds_read_b64_tr_b16 v[122:123], v13 offset:37408
    ds_write_b32 v254, v56 offset:0
    ds_write_b32 v254, v60 offset:512
    s_waitcnt lgkmcnt(6)
    v_mfma_f32_32x32x16_bf16 v[80:95], v[112:115], v[232:235], v[80:95]
    ds_read_b64_tr_b16 v[124:125], v12 offset:37440
    ds_read_b64_tr_b16 v[126:127], v13 offset:37440
    s_waitcnt lgkmcnt(2)
    s_barrier
    v_mfma_f32_32x32x16_bf16 v[96:111], v[116:119], v[232:235], v[96:111]
    ds_read_b64_tr_b16 v[112:113], v20 offset:0
    ds_read_b64_tr_b16 v[114:115], v20 offset:512
    ds_read_b128 v[250:253], v255 offset:0
    v_mfma_f32_32x32x16_bf16 v[80:95], v[120:123], v[236:239], v[80:95]
    ds_read_b64_tr_b16 v[116:117], v21 offset:0
    ds_read_b64_tr_b16 v[118:119], v21 offset:512
    s_waitcnt lgkmcnt(5)
    v_mfma_f32_32x32x16_bf16 v[96:111], v[124:127], v[236:239], v[96:111]
    ds_read_b64_tr_b16 v[120:121], v20 offset:2048
    ds_read_b64_tr_b16 v[122:123], v20 offset:2560
    s_waitcnt lgkmcnt(4)
    v_add_f32 v250, v250, v251
    v_add_f32 v252, v252, v253
    v_add_f32 v250, v250, v252
    v_and_b32 v251, 0xffff0000, v250
    v_sub_f32 v251, v250, v251
    v_and_b32 v252, 0xffff0000, v251
    v_perm_b32 v244, v251, v250, s83
    v_sub_f32 v252, v251, v252
    v_lshrrev_b32 v245, 16, v252
    v_mfma_f32_32x32x16_bf16 v[32:47], v[112:115], v[128:131], 0
    s_nop 0
    v_mfma_f32_32x32x16_bf16 v[80:95], v[244:247], v[246:249], v[80:95]
    ds_read_b64_tr_b16 v[124:125], v21 offset:2048
    ds_read_b64_tr_b16 v[126:127], v21 offset:2560
    ds_read_b128 v[250:253], v255 offset:512
    s_waitcnt vmcnt(0)
    v_mov_b32 v28, s56
    v_mov_b32 v29, s57
    s_mov_b64 exec, 1
    buffer_store_dwordx2 v[28:29], off, s[32:35], s69 offset:0 sc1
    s_mov_b64 exec, -1
    s_waitcnt lgkmcnt(5)
    v_mfma_f32_32x32x16_bf16 v[48:63], v[116:119], v[128:131], 0
    ds_read_b64_tr_b16 v[112:113], v20 offset:4096
    ds_read_b64_tr_b16 v[114:115], v20 offset:4608
    s_waitcnt lgkmcnt(5)
    v_mfma_f32_32x32x16_bf16 v[32:47], v[120:123], v[132:135], v[32:47]
    ds_read_b64_tr_b16 v[116:117], v21 offset:4096
    ds_read_b64_tr_b16 v[118:119], v21 offset:4608
    s_waitcnt lgkmcnt(4)
    v_add_f32 v250, v250, v251
    v_add_f32 v252, v252, v253
    v_add_f32 v250, v250, v252
    v_and_b32 v251, 0xffff0000, v250
    v_sub_f32 v251, v250, v251
    v_and_b32 v252, 0xffff0000, v251
    v_perm_b32 v244, v251, v250, s83
    v_sub_f32 v252, v251, v252
    v_lshrrev_b32 v245, 16, v252
    v_mfma_f32_32x32x16_bf16 v[48:63], v[124:127], v[132:135], v[48:63]
    s_nop 0
    v_mfma_f32_32x32x16_bf16 v[96:111], v[244:247], v[246:249], v[96:111]
    ds_read_b64_tr_b16 v[120:121], v20 offset:6144
    ds_read_b64_tr_b16 v[122:123], v20 offset:6656
    s_waitcnt lgkmcnt(4)
    v_mfma_f32_32x32x16_bf16 v[32:47], v[112:115], v[136:139], v[32:47]
    s_barrier
    ds_read_b64_tr_b16 v[124:125], v21 offset:6144
    ds_read_b64_tr_b16 v[126:127], v21 offset:6656
    s_lshl_b32 s67, s58, 11
    v_add_u32 v16, s67, v20
    ds_read_b64_tr_b16 v[250:251], v16 offset:0
    ds_read_b64_tr_b16 v[252:253], v16 offset:512
    s_waitcnt lgkmcnt(6)
    v_mfma_f32_32x32x16_bf16 v[48:63], v[116:119], v[136:139], v[48:63]
    ds_read_b64_tr_b16 v[112:113], v20 offset:16384
    ds_read_b64_tr_b16 v[114:115], v20 offset:16896
    s_waitcnt lgkmcnt(6)
    v_mfma_f32_32x32x16_bf16 v[32:47], v[120:123], v[140:143], v[32:47]
    s_waitcnt lgkmcnt(2)
    v_mfma_f32_16x16x32_bf16 v[8:11], v[240:243], v[250:253], 0
    ds_read_b64_tr_b16 v[116:117], v21 offset:16384
    ds_read_b64_tr_b16 v[118:119], v21 offset:16896
    s_lshl_b32 s67, s58, 11
    v_add_u32 v22, s67, v21
    ds_read_b64_tr_b16 v[250:251], v22 offset:0
    ds_read_b64_tr_b16 v[252:253], v22 offset:512
    v_mfma_f32_32x32x16_bf16 v[48:63], v[124:127], v[140:143], v[48:63]
    ds_read_b64_tr_b16 v[120:121], v20 offset:18432
    ds_read_b64_tr_b16 v[122:123], v20 offset:18944
    v_mul_f32 v24, v80, v80
    v_mul_f32 v25, v81, v81
    v_mul_f32 v26, v82, v82
    v_mul_f32 v27, v83, v83
    v_fma_f32 v24, v24, v7, v6
    v_fma_f32 v25, v25, v7, v6
    v_fma_f32 v26, v26, v7, v6
    v_fma_f32 v27, v27, v7, v6
    v_mul_f32 v24, v24, v80
    s_waitcnt lgkmcnt(6)
    v_mfma_f32_32x32x16_bf16 v[32:47], v[112:115], v[144:147], v[32:47]
    s_waitcnt lgkmcnt(2)
    v_mfma_f32_16x16x32_bf16 v[12:15], v[240:243], v[250:253], 0
    ds_read_b64_tr_b16 v[124:125], v21 offset:18432
    ds_read_b64_tr_b16 v[126:127], v21 offset:18944
    ds_read_b64_tr_b16 v[250:251], v16 offset:16384
    ds_read_b64_tr_b16 v[252:253], v16 offset:16896
    v_mul_f32 v25, v25, v81
    v_mul_f32 v26, v26, v82
    v_mul_f32 v27, v27, v83
    v_exp_f32 v24, v24
    v_exp_f32 v25, v25
    v_exp_f32 v26, v26
    v_mfma_f32_32x32x16_bf16 v[48:63], v[116:119], v[144:147], v[48:63]
    ds_read_b64_tr_b16 v[112:113], v20 offset:20480
    ds_read_b64_tr_b16 v[114:115], v20 offset:20992
    v_exp_f32 v27, v27
    v_mul_f32 v88, v80, v88
    v_mul_f32 v89, v81, v89
    v_mul_f32 v90, v82, v90
    v_mul_f32 v91, v83, v91
    v_fma_f32 v24, v24, v4, v4
    s_waitcnt lgkmcnt(6)
    v_mfma_f32_32x32x16_bf16 v[32:47], v[120:123], v[148:151], v[32:47]
    s_waitcnt lgkmcnt(2)
    v_mfma_f32_16x16x32_bf16 v[8:11], v[240:243], v[250:253], v[8:11]
    ds_read_b64_tr_b16 v[116:117], v21 offset:20480
    ds_read_b64_tr_b16 v[118:119], v21 offset:20992
    ds_read_b64_tr_b16 v[250:251], v22 offset:16384
    ds_read_b64_tr_b16 v[252:253], v22 offset:16896
    v_fma_f32 v25, v25, v4, v4
    v_fma_f32 v26, v26, v4, v4
    v_fma_f32 v27, v27, v4, v4
    v_rcp_f32 v24, v24
    v_rcp_f32 v25, v25
    v_rcp_f32 v26, v26
    v_mfma_f32_32x32x16_bf16 v[48:63], v[124:127], v[148:151], v[48:63]
    ds_read_b64_tr_b16 v[120:121], v20 offset:22528
    ds_read_b64_tr_b16 v[122:123], v20 offset:23040
    v_rcp_f32 v27, v27
    v_mul_f32 v88, v88, v24
    v_mul_f32 v89, v89, v25
    v_mul_f32 v90, v90, v26
    v_mul_f32 v91, v91, v27
    v_mul_f32 v24, v84, v84
    s_waitcnt lgkmcnt(6)
    v_mfma_f32_32x32x16_bf16 v[32:47], v[112:115], v[152:155], v[32:47]
    s_barrier
    s_waitcnt lgkmcnt(2)
    v_mfma_f32_16x16x32_bf16 v[12:15], v[240:243], v[250:253], v[12:15]
    ds_read_b64_tr_b16 v[124:125], v21 offset:22528
    ds_read_b64_tr_b16 v[126:127], v21 offset:23040
    v_mul_f32 v25, v85, v85
    v_mul_f32 v26, v86, v86
    v_mul_f32 v27, v87, v87
    v_fma_f32 v24, v24, v7, v6
    v_fma_f32 v25, v25, v7, v6
    v_fma_f32 v26, v26, v7, v6
    v_fma_f32 v27, v27, v7, v6
    v_mul_f32 v24, v24, v84
    v_mul_f32 v25, v25, v85
    v_mfma_f32_32x32x16_bf16 v[48:63], v[116:119], v[152:155], v[48:63]
    ds_read_b64_tr_b16 v[112:113], v20 offset:32768
    ds_read_b64_tr_b16 v[114:115], v20 offset:33280
    ds_read_b64_tr_b16 v[250:251], v16 offset:32768
    ds_read_b64_tr_b16 v[252:253], v16 offset:33280
    v_mul_f32 v26, v26, v86
    v_mul_f32 v27, v27, v87
    v_exp_f32 v24, v24
    v_exp_f32 v25, v25
    v_exp_f32 v26, v26
    s_waitcnt lgkmcnt(6)
    v_mfma_f32_32x32x16_bf16 v[32:47], v[120:123], v[156:159], v[32:47]
    ds_read_b64_tr_b16 v[116:117], v21 offset:32768
    ds_read_b64_tr_b16 v[118:119], v21 offset:33280
    v_exp_f32 v27, v27
    v_mul_f32 v92, v84, v92
    v_mul_f32 v93, v85, v93
    v_mul_f32 v94, v86, v94
    v_mul_f32 v95, v87, v95
    v_fma_f32 v24, v24, v4, v4
    v_fma_f32 v25, v25, v4, v4
    s_waitcnt lgkmcnt(6)
    v_mfma_f32_32x32x16_bf16 v[48:63], v[124:127], v[156:159], v[48:63]
    s_waitcnt lgkmcnt(2)
    v_mfma_f32_16x16x32_bf16 v[8:11], v[240:243], v[250:253], v[8:11]
    ds_read_b64_tr_b16 v[120:121], v20 offset:34816
    ds_read_b64_tr_b16 v[122:123], v20 offset:35328
    ds_read_b64_tr_b16 v[250:251], v22 offset:32768
    ds_read_b64_tr_b16 v[252:253], v22 offset:33280
    v_fma_f32 v26, v26, v4, v4
    v_fma_f32 v27, v27, v4, v4
    v_rcp_f32 v24, v24
    v_rcp_f32 v25, v25
    v_rcp_f32 v26, v26
    v_mfma_f32_32x32x16_bf16 v[32:47], v[112:115], v[160:163], v[32:47]
    ds_read_b64_tr_b16 v[124:125], v21 offset:34816
    ds_read_b64_tr_b16 v[126:127], v21 offset:35328
    v_rcp_f32 v27, v27
    v_mul_f32 v92, v92, v24
    v_mul_f32 v93, v93, v25
    v_mul_f32 v94, v94, v26
    v_mul_f32 v95, v95, v27
    v_cvt_pk_bf16_f32 v80, v88, v89
    v_cvt_pk_bf16_f32 v81, v90, v91
    s_waitcnt lgkmcnt(6)
    v_mfma_f32_32x32x16_bf16 v[48:63], v[116:119], v[160:163], v[48:63]
    s_waitcnt lgkmcnt(2)
    v_mfma_f32_16x16x32_bf16 v[12:15], v[240:243], v[250:253], v[12:15]
    ds_read_b64_tr_b16 v[112:113], v20 offset:36864
    ds_read_b64_tr_b16 v[114:115], v20 offset:37376
    v_cvt_pk_bf16_f32 v82, v92, v93
    v_cvt_pk_bf16_f32 v83, v94, v95
    s_cmp_gt_u32 s52, 1
    s_cselect_b32 s65, 1, 5
    s_mul_i32 s66, s51, 7
    s_add_u32 s65, s65, s66
    s_lshl_b32 s65, s65, 10
    s_add_u32 s65, s65, s63
    buffer_store_dwordx4 v[80:83], v2, s[32:35], s65 offen sc1
    v_mul_f32 v24, v96, v96
    v_mul_f32 v25, v97, v97
    v_mul_f32 v26, v98, v98
    v_mul_f32 v27, v99, v99
    v_fma_f32 v24, v24, v7, v6
    v_mfma_f32_32x32x16_bf16 v[32:47], v[120:123], v[164:167], v[32:47]
    ds_read_b64_tr_b16 v[116:117], v21 offset:36864
    ds_read_b64_tr_b16 v[118:119], v21 offset:37376
    v_fma_f32 v25, v25, v7, v6
    v_fma_f32 v26, v26, v7, v6
    v_fma_f32 v27, v27, v7, v6
    v_mul_f32 v24, v24, v96
    v_mul_f32 v25, v25, v97
    v_mul_f32 v26, v26, v98
    v_mul_f32 v27, v27, v99
    v_exp_f32 v24, v24
    s_waitcnt lgkmcnt(4)
    v_mfma_f32_32x32x16_bf16 v[48:63], v[124:127], v[164:167], v[48:63]
    ds_read_b64_tr_b16 v[120:121], v20 offset:38912
    ds_read_b64_tr_b16 v[122:123], v20 offset:39424
    v_exp_f32 v25, v25
    v_exp_f32 v26, v26
    v_exp_f32 v27, v27
    v_mul_f32 v104, v96, v104
    s_waitcnt lgkmcnt(4)
    v_mfma_f32_32x32x16_bf16 v[32:47], v[112:115], v[168:171], v[32:47]
    s_barrier
    ds_read_b64_tr_b16 v[124:125], v21 offset:38912
    ds_read_b64_tr_b16 v[126:127], v21 offset:39424
    v_mul_f32 v105, v97, v105
    v_mul_f32 v106, v98, v106
    v_mul_f32 v107, v99, v107
    v_fma_f32 v24, v24, v4, v4
    v_fma_f32 v25, v25, v4, v4
    v_fma_f32 v26, v26, v4, v4
    v_fma_f32 v27, v27, v4, v4
    v_rcp_f32 v24, v24
    s_waitcnt lgkmcnt(4)
    v_mfma_f32_32x32x16_bf16 v[48:63], v[116:119], v[168:171], v[48:63]
    ds_read_b64_tr_b16 v[112:113], v20 offset:49152
    ds_read_b64_tr_b16 v[114:115], v20 offset:49664
    ds_read_b64_tr_b16 v[250:251], v16 offset:49152
    ds_read_b64_tr_b16 v[252:253], v16 offset:49664
    v_rcp_f32 v25, v25
    v_rcp_f32 v26, v26
    v_rcp_f32 v27, v27
    v_mul_f32 v104, v104, v24
    s_waitcnt lgkmcnt(6)
    v_mfma_f32_32x32x16_bf16 v[32:47], v[120:123], v[172:175], v[32:47]
    ds_read_b64_tr_b16 v[116:117], v21 offset:49152
    ds_read_b64_tr_b16 v[118:119], v21 offset:49664
    v_mul_f32 v105, v105, v25
    v_mul_f32 v106, v106, v26
    v_mul_f32 v107, v107, v27
    v_mul_f32 v24, v100, v100
    v_mul_f32 v25, v101, v101
    v_mul_f32 v26, v102, v102
    v_mul_f32 v27, v103, v103
    v_fma_f32 v24, v24, v7, v6
    v_fma_f32 v25, v25, v7, v6
    s_waitcnt lgkmcnt(6)
    v_mfma_f32_32x32x16_bf16 v[48:63], v[124:127], v[172:175], v[48:63]
    s_waitcnt lgkmcnt(2)
    v_mfma_f32_16x16x32_bf16 v[8:11], v[240:243], v[250:253], v[8:11]
    ds_read_b64_tr_b16 v[120:121], v20 offset:51200
    ds_read_b64_tr_b16 v[122:123], v20 offset:51712
    ds_read_b64_tr_b16 v[250:251], v22 offset:49152
    ds_read_b64_tr_b16 v[252:253], v22 offset:49664
    v_fma_f32 v26, v26, v7, v6
    v_fma_f32 v27, v27, v7, v6
    v_mul_f32 v24, v24, v100
    v_mul_f32 v25, v25, v101
    v_mul_f32 v26, v26, v102
    v_mul_f32 v27, v27, v103
    v_exp_f32 v24, v24
    v_mfma_f32_32x32x16_bf16 v[32:47], v[112:115], v[176:179], v[32:47]
    ds_read_b64_tr_b16 v[124:125], v21 offset:51200
    ds_read_b64_tr_b16 v[126:127], v21 offset:51712
    v_exp_f32 v25, v25
    v_exp_f32 v26, v26
    v_exp_f32 v27, v27
    v_mul_f32 v108, v100, v108
    v_mul_f32 v109, v101, v109
    s_waitcnt lgkmcnt(6)
    v_mfma_f32_32x32x16_bf16 v[48:63], v[116:119], v[176:179], v[48:63]
    s_waitcnt lgkmcnt(2)
    v_mfma_f32_16x16x32_bf16 v[12:15], v[240:243], v[250:253], v[12:15]
    ds_read_b64_tr_b16 v[112:113], v20 offset:53248
    ds_read_b64_tr_b16 v[114:115], v20 offset:53760
    v_mul_f32 v110, v102, v110
    v_mul_f32 v111, v103, v111
    v_fma_f32 v24, v24, v4, v4
    v_fma_f32 v25, v25, v4, v4
    v_fma_f32 v26, v26, v4, v4
    v_fma_f32 v27, v27, v4, v4
    v_rcp_f32 v24, v24
    v_mfma_f32_32x32x16_bf16 v[32:47], v[120:123], v[180:183], v[32:47]
    ds_read_b64_tr_b16 v[116:117], v21 offset:53248
    ds_read_b64_tr_b16 v[118:119], v21 offset:53760
    v_rcp_f32 v25, v25
    v_rcp_f32 v26, v26
    v_rcp_f32 v27, v27
    v_mul_f32 v108, v108, v24
    v_mul_f32 v109, v109, v25
    s_waitcnt lgkmcnt(4)
    v_mfma_f32_32x32x16_bf16 v[48:63], v[124:127], v[180:183], v[48:63]
    ds_read_b64_tr_b16 v[120:121], v20 offset:55296
    ds_read_b64_tr_b16 v[122:123], v20 offset:55808
    v_mul_f32 v110, v110, v26
    v_mul_f32 v111, v111, v27
    v_cvt_pk_bf16_f32 v96, v104, v105
    v_cvt_pk_bf16_f32 v97, v106, v107
    v_cvt_pk_bf16_f32 v98, v108, v109
    v_cvt_pk_bf16_f32 v99, v110, v111
    s_cmp_gt_u32 s52, 2
    s_cselect_b32 s65, 2, 6
    s_mul_i32 s66, s51, 7
    s_add_u32 s65, s65, s66
    s_lshl_b32 s65, s65, 10
    s_add_u32 s65, s65, s63
    buffer_store_dwordx4 v[96:99], v2, s[32:35], s65 offen sc1
    s_waitcnt lgkmcnt(4)
    v_mfma_f32_32x32x16_bf16 v[32:47], v[112:115], v[184:187], v[32:47]
    s_barrier
    ds_read_b64_tr_b16 v[124:125], v21 offset:55296
    ds_read_b64_tr_b16 v[126:127], v21 offset:55808
    s_waitcnt lgkmcnt(4)
    v_mfma_f32_32x32x16_bf16 v[48:63], v[116:119], v[184:187], v[48:63]
    v_add_u32 v20, 0x00010000, v20
    ds_read_b64_tr_b16 v[112:113], v20 offset:0
    ds_read_b64_tr_b16 v[114:115], v20 offset:512
    v_add_u32 v16, 0x00010000, v16
    ds_read_b64_tr_b16 v[250:251], v16 offset:0
    ds_read_b64_tr_b16 v[252:253], v16 offset:512
    s_waitcnt lgkmcnt(6)
    v_mfma_f32_32x32x16_bf16 v[32:47], v[120:123], v[188:191], v[32:47]
    v_add_u32 v21, 0x00010000, v21
    ds_read_b64_tr_b16 v[116:117], v21 offset:0
    ds_read_b64_tr_b16 v[118:119], v21 offset:512
    s_waitcnt lgkmcnt(6)
    v_mfma_f32_32x32x16_bf16 v[48:63], v[124:127], v[188:191], v[48:63]
    s_waitcnt lgkmcnt(2)
    v_mfma_f32_16x16x32_bf16 v[8:11], v[240:243], v[250:253], v[8:11]
    ds_read_b64_tr_b16 v[120:121], v20 offset:2048
    ds_read_b64_tr_b16 v[122:123], v20 offset:2560
    v_add_u32 v22, 0x00010000, v22
    ds_read_b64_tr_b16 v[250:251], v22 offset:0
    ds_read_b64_tr_b16 v[252:253], v22 offset:512
    v_mfma_f32_32x32x16_bf16 v[32:47], v[112:115], v[192:195], v[32:47]
    ds_read_b64_tr_b16 v[124:125], v21 offset:2048
    ds_read_b64_tr_b16 v[126:127], v21 offset:2560
    s_waitcnt lgkmcnt(6)
    v_mfma_f32_32x32x16_bf16 v[48:63], v[116:119], v[192:195], v[48:63]
    s_waitcnt lgkmcnt(2)
    v_mfma_f32_16x16x32_bf16 v[12:15], v[240:243], v[250:253], v[12:15]
    ds_read_b64_tr_b16 v[112:113], v20 offset:4096
    ds_read_b64_tr_b16 v[114:115], v20 offset:4608
    v_mfma_f32_32x32x16_bf16 v[32:47], v[120:123], v[196:199], v[32:47]
    ds_read_b64_tr_b16 v[116:117], v21 offset:4096
    ds_read_b64_tr_b16 v[118:119], v21 offset:4608
    s_waitcnt lgkmcnt(4)
    v_mfma_f32_32x32x16_bf16 v[48:63], v[124:127], v[196:199], v[48:63]
    ds_read_b64_tr_b16 v[120:121], v20 offset:6144
    ds_read_b64_tr_b16 v[122:123], v20 offset:6656
    s_waitcnt lgkmcnt(4)
    v_mfma_f32_32x32x16_bf16 v[32:47], v[112:115], v[200:203], v[32:47]
    s_barrier
    ds_read_b64_tr_b16 v[124:125], v21 offset:6144
    ds_read_b64_tr_b16 v[126:127], v21 offset:6656
    v_and_b32 v23, 15, v1
    v_lshlrev_b32 v23, 3, v23
    s_lshl_b32 s68, s50, 16
    s_lshl_b32 s66, s58, 10
    s_add_u32 s68, s68, s66
    s_add_u32 s68, s68, 262144
    buffer_load_dwordx2 v[28:29], v23, s[32:35], s82 offen sc1
    s_waitcnt vmcnt(1)
    v_mov_b32 v24, s56
    v_mov_b32 v25, s57
    s_mov_b64 exec, 1
    buffer_store_dwordx2 v[24:25], off, s[32:35], s78 offset:128 sc1
    s_mov_b64 exec, -1
    s_waitcnt lgkmcnt(4)
    v_mfma_f32_32x32x16_bf16 v[48:63], v[116:119], v[200:203], v[48:63]
    ds_read_b64_tr_b16 v[112:113], v20 offset:16384
    ds_read_b64_tr_b16 v[114:115], v20 offset:16896
    ds_read_b64_tr_b16 v[250:251], v16 offset:16384
    ds_read_b64_tr_b16 v[252:253], v16 offset:16896
    s_waitcnt lgkmcnt(6)
    v_mfma_f32_32x32x16_bf16 v[32:47], v[120:123], v[204:207], v[32:47]
    ds_read_b64_tr_b16 v[116:117], v21 offset:16384
    ds_read_b64_tr_b16 v[118:119], v21 offset:16896
    s_waitcnt lgkmcnt(6)
    v_mfma_f32_32x32x16_bf16 v[48:63], v[124:127], v[204:207], v[48:63]
    s_waitcnt lgkmcnt(2)
    v_mfma_f32_16x16x32_bf16 v[8:11], v[240:243], v[250:253], v[8:11]
    ds_read_b64_tr_b16 v[120:121], v20 offset:18432
    ds_read_b64_tr_b16 v[122:123], v20 offset:18944
    ds_read_b64_tr_b16 v[250:251], v22 offset:16384
    ds_read_b64_tr_b16 v[252:253], v22 offset:16896
    v_mfma_f32_32x32x16_bf16 v[32:47], v[112:115], v[208:211], v[32:47]
    ds_read_b64_tr_b16 v[124:125], v21 offset:18432
    ds_read_b64_tr_b16 v[126:127], v21 offset:18944
    s_waitcnt lgkmcnt(6)
    v_mfma_f32_32x32x16_bf16 v[48:63], v[116:119], v[208:211], v[48:63]
    s_waitcnt lgkmcnt(2)
    v_mfma_f32_16x16x32_bf16 v[12:15], v[240:243], v[250:253], v[12:15]
    ds_read_b64_tr_b16 v[112:113], v20 offset:20480
    ds_read_b64_tr_b16 v[114:115], v20 offset:20992
    v_mfma_f32_32x32x16_bf16 v[32:47], v[120:123], v[212:215], v[32:47]
    ds_read_b64_tr_b16 v[116:117], v21 offset:20480
    ds_read_b64_tr_b16 v[118:119], v21 offset:20992
    s_waitcnt vmcnt(1)
    v_cmp_ne_u64 vcc, s[56:57], v[28:29]
    s_cbranch_vccnz L_slow_kv
L_res_kv:
    buffer_load_dwordx4 v[64:67], v2, s[32:35], s68 offen sc1
    s_add_u32 s68, s68, 4096
    s_waitcnt lgkmcnt(4)
    v_mfma_f32_32x32x16_bf16 v[48:63], v[124:127], v[212:215], v[48:63]
    ds_read_b64_tr_b16 v[120:121], v20 offset:22528
    ds_read_b64_tr_b16 v[122:123], v20 offset:23040
    buffer_load_dwordx4 v[68:71], v2, s[32:35], s68 offen sc1
    s_add_u32 s68, s68, 4096
    s_waitcnt lgkmcnt(4)
    v_mfma_f32_32x32x16_bf16 v[32:47], v[112:115], v[216:219], v[32:47]
    s_barrier
    ds_read_b64_tr_b16 v[124:125], v21 offset:22528
    ds_read_b64_tr_b16 v[126:127], v21 offset:23040
    buffer_load_dwordx4 v[72:75], v2, s[32:35], s68 offen sc1
    s_add_u32 s68, s68, 4096
    s_waitcnt lgkmcnt(4)
    v_mfma_f32_32x32x16_bf16 v[48:63], v[116:119], v[216:219], v[48:63]
    ds_read_b64_tr_b16 v[112:113], v20 offset:32768
    ds_read_b64_tr_b16 v[114:115], v20 offset:33280
    ds_read_b64_tr_b16 v[250:251], v16 offset:32768
    ds_read_b64_tr_b16 v[252:253], v16 offset:33280
    buffer_load_dwordx4 v[76:79], v2, s[32:35], s68 offen sc1
    s_add_u32 s68, s68, 4096
    s_waitcnt lgkmcnt(6)
    v_mfma_f32_32x32x16_bf16 v[32:47], v[120:123], v[220:223], v[32:47]
    ds_read_b64_tr_b16 v[116:117], v21 offset:32768
    ds_read_b64_tr_b16 v[118:119], v21 offset:33280
    buffer_load_dwordx4 v[80:83], v2, s[32:35], s68 offen sc1
    s_add_u32 s68, s68, 4096
    s_waitcnt lgkmcnt(6)
    v_mfma_f32_32x32x16_bf16 v[48:63], v[124:127], v[220:223], v[48:63]
    s_waitcnt lgkmcnt(2)
    v_mfma_f32_16x16x32_bf16 v[8:11], v[240:243], v[250:253], v[8:11]
    ds_read_b64_tr_b16 v[120:121], v20 offset:34816
    ds_read_b64_tr_b16 v[122:123], v20 offset:35328
    ds_read_b64_tr_b16 v[250:251], v22 offset:32768
    ds_read_b64_tr_b16 v[252:253], v22 offset:33280
    buffer_load_dwordx4 v[84:87], v2, s[32:35], s68 offen sc1
    s_add_u32 s68, s68, 4096
    v_mfma_f32_32x32x16_bf16 v[32:47], v[112:115], v[224:227], v[32:47]
    ds_read_b64_tr_b16 v[124:125], v21 offset:34816
    ds_read_b64_tr_b16 v[126:127], v21 offset:35328
    s_waitcnt lgkmcnt(6)
    v_mfma_f32_32x32x16_bf16 v[48:63], v[116:119], v[224:227], v[48:63]
    s_waitcnt lgkmcnt(2)
    v_mfma_f32_16x16x32_bf16 v[12:15], v[240:243], v[250:253], v[12:15]
    ds_read_b64_tr_b16 v[112:113], v20 offset:36864
    ds_read_b64_tr_b16 v[114:115], v20 offset:37376
    buffer_load_dwordx4 v[88:91], v2, s[32:35], s68 offen sc1
    s_add_u32 s68, s68, 4096
    v_mfma_f32_32x32x16_bf16 v[32:47], v[120:123], v[228:231], v[32:47]
    ds_read_b64_tr_b16 v[116:117], v21 offset:36864
    ds_read_b64_tr_b16 v[118:119], v21 offset:37376
    buffer_load_dwordx4 v[92:95], v2, s[32:35], s68 offen sc1
    s_add_u32 s68, s68, 4096
    s_waitcnt lgkmcnt(4)
    v_mfma_f32_32x32x16_bf16 v[48:63], v[124:127], v[228:231], v[48:63]
    ds_read_b64_tr_b16 v[120:121], v20 offset:38912
    ds_read_b64_tr_b16 v[122:123], v20 offset:39424
    ds_write_b32 v254, v8 offset:0
    ds_write_b32 v254, v12 offset:512
    buffer_load_dwordx4 v[96:99], v2, s[32:35], s68 offen sc1
    s_add_u32 s68, s68, 4096
    s_waitcnt lgkmcnt(6)
    v_mfma_f32_32x32x16_bf16 v[32:47], v[112:115], v[232:235], v[32:47]
    ds_read_b64_tr_b16 v[124:125], v21 offset:38912
    ds_read_b64_tr_b16 v[126:127], v21 offset:39424
    buffer_load_dwordx4 v[100:103], v2, s[32:35], s68 offen sc1
    s_add_u32 s68, s68, 4096
    s_waitcnt lgkmcnt(2)
    s_barrier
    v_and_b32 v22, 31, v1
    v_lshlrev_b32 v22, 3, v22
    buffer_load_dwordx2 v[26:27], v22, s[32:35], s74 offen sc1
    v_mfma_f32_32x32x16_bf16 v[48:63], v[116:119], v[232:235], v[48:63]
    buffer_load_dwordx4 v[104:107], v2, s[32:35], s68 offen sc1
    s_add_u32 s68, s68, 4096
    ds_read_b128 v[250:253], v255 offset:0
    v_mfma_f32_32x32x16_bf16 v[32:47], v[120:123], v[236:239], v[32:47]
    buffer_load_dwordx4 v[108:111], v2, s[32:35], s68 offen sc1
    s_add_u32 s68, s68, 4096
    s_waitcnt lgkmcnt(1)
    v_mfma_f32_32x32x16_bf16 v[48:63], v[124:127], v[236:239], v[48:63]
    s_waitcnt lgkmcnt(0)
    v_add_f32 v250, v250, v251
    v_add_f32 v252, v252, v253
    v_add_f32 v250, v250, v252
    v_and_b32 v251, 0xffff0000, v250
    v_sub_f32 v251, v250, v251
    v_and_b32 v252, 0xffff0000, v251
    v_perm_b32 v244, v251, v250, s83
    v_sub_f32 v252, v251, v252
    v_lshrrev_b32 v245, 16, v252
    s_nop 1
    v_mfma_f32_32x32x16_bf16 v[32:47], v[244:247], v[246:249], v[32:47]
    ds_read_b128 v[250:253], v255 offset:512
    s_waitcnt lgkmcnt(0)
    v_add_f32 v250, v250, v251
    v_add_f32 v252, v252, v253
    v_add_f32 v250, v250, v252
    v_and_b32 v251, 0xffff0000, v250
    v_sub_f32 v251, v250, v251
    v_and_b32 v252, 0xffff0000, v251
    v_perm_b32 v244, v251, v250, s83
    v_sub_f32 v252, v251, v252
    v_lshrrev_b32 v245, 16, v252
    s_nop 1
    v_mfma_f32_32x32x16_bf16 v[48:63], v[244:247], v[246:249], v[48:63]
    s_setprio 1
    v_pk_mul_f32 v[112:113], v[32:33], v[32:33]
    v_pk_mul_f32 v[114:115], v[34:35], v[34:35]
    v_pk_mul_f32 v[116:117], v[36:37], v[36:37]
    v_pk_mul_f32 v[118:119], v[38:39], v[38:39]
    v_pk_fma_f32 v[112:113], v[112:113], v[6:7], v[6:7] op_sel:[0,1,0] op_sel_hi:[1,1,0]
    v_pk_fma_f32 v[114:115], v[114:115], v[6:7], v[6:7] op_sel:[0,1,0] op_sel_hi:[1,1,0]
    v_pk_fma_f32 v[116:117], v[116:117], v[6:7], v[6:7] op_sel:[0,1,0] op_sel_hi:[1,1,0]
    v_pk_fma_f32 v[118:119], v[118:119], v[6:7], v[6:7] op_sel:[0,1,0] op_sel_hi:[1,1,0]
    v_pk_mul_f32 v[112:113], v[112:113], v[32:33]
    v_pk_mul_f32 v[114:115], v[114:115], v[34:35]
    v_pk_mul_f32 v[116:117], v[116:117], v[36:37]
    v_pk_mul_f32 v[118:119], v[118:119], v[38:39]
    v_exp_f32 v112, v112
    v_exp_f32 v113, v113
    v_exp_f32 v114, v114
    v_exp_f32 v115, v115
    v_exp_f32 v116, v116
    v_exp_f32 v117, v117
    v_exp_f32 v118, v118
    v_exp_f32 v119, v119
    v_pk_mul_f32 v[40:41], v[32:33], v[40:41]
    v_pk_mul_f32 v[42:43], v[34:35], v[42:43]
    v_pk_mul_f32 v[44:45], v[36:37], v[44:45]
    v_pk_mul_f32 v[46:47], v[38:39], v[46:47]
    v_pk_fma_f32 v[112:113], v[112:113], v[4:5], v[4:5] op_sel_hi:[1,0,0]
    v_pk_fma_f32 v[114:115], v[114:115], v[4:5], v[4:5] op_sel_hi:[1,0,0]
    v_pk_fma_f32 v[116:117], v[116:117], v[4:5], v[4:5] op_sel_hi:[1,0,0]
    v_pk_fma_f32 v[118:119], v[118:119], v[4:5], v[4:5] op_sel_hi:[1,0,0]
    v_rcp_f32 v112, v112
    v_rcp_f32 v113, v113
    v_rcp_f32 v114, v114
    v_rcp_f32 v115, v115
    v_rcp_f32 v116, v116
    v_rcp_f32 v117, v117
    v_rcp_f32 v118, v118
    v_rcp_f32 v119, v119
    v_pk_mul_f32 v[40:41], v[40:41], v[112:113]
    v_pk_mul_f32 v[42:43], v[42:43], v[114:115]
    v_pk_mul_f32 v[44:45], v[44:45], v[116:117]
    v_pk_mul_f32 v[46:47], v[46:47], v[118:119]
    v_cvt_pk_bf16_f32 v32, v40, v41
    v_cvt_pk_bf16_f32 v33, v42, v43
    v_cvt_pk_bf16_f32 v34, v44, v45
    v_cvt_pk_bf16_f32 v35, v46, v47
    s_mul_i32 s65, s51, 7
    s_add_u32 s65, s65, s52
    s_add_u32 s65, s65, 2
    s_lshl_b32 s65, s65, 10
    s_add_u32 s65, s65, s63
    buffer_store_dwordx4 v[32:35], v2, s[32:35], s65 offen sc1
    buffer_load_dwordx4 v[36:39], v2, s[32:35], s68 offen sc1
    s_add_u32 s68, s68, 4096
    v_pk_mul_f32 v[112:113], v[48:49], v[48:49]
    v_pk_mul_f32 v[114:115], v[50:51], v[50:51]
    v_pk_mul_f32 v[116:117], v[52:53], v[52:53]
    v_pk_mul_f32 v[118:119], v[54:55], v[54:55]
    v_pk_fma_f32 v[112:113], v[112:113], v[6:7], v[6:7] op_sel:[0,1,0] op_sel_hi:[1,1,0]
    v_pk_fma_f32 v[114:115], v[114:115], v[6:7], v[6:7] op_sel:[0,1,0] op_sel_hi:[1,1,0]
    v_pk_fma_f32 v[116:117], v[116:117], v[6:7], v[6:7] op_sel:[0,1,0] op_sel_hi:[1,1,0]
    v_pk_fma_f32 v[118:119], v[118:119], v[6:7], v[6:7] op_sel:[0,1,0] op_sel_hi:[1,1,0]
    v_pk_mul_f32 v[112:113], v[112:113], v[48:49]
    v_pk_mul_f32 v[114:115], v[114:115], v[50:51]
    buffer_load_dwordx4 v[40:43], v2, s[32:35], s68 offen sc1
    s_add_u32 s68, s68, 4096
    v_pk_mul_f32 v[116:117], v[116:117], v[52:53]
    v_pk_mul_f32 v[118:119], v[118:119], v[54:55]
    v_exp_f32 v112, v112
    v_exp_f32 v113, v113
    v_exp_f32 v114, v114
    v_exp_f32 v115, v115
    buffer_load_dwordx4 v[44:47], v2, s[32:35], s68 offen sc1
    s_add_u32 s68, s68, 4096
    v_exp_f32 v116, v116
    v_exp_f32 v117, v117
    v_exp_f32 v118, v118
    v_exp_f32 v119, v119
    buffer_load_dwordx4 v[224:227], v2, s[32:35], s68 offen sc1
    s_add_u32 s68, s68, 4096
    v_pk_mul_f32 v[56:57], v[48:49], v[56:57]
    v_pk_mul_f32 v[58:59], v[50:51], v[58:59]
    v_pk_mul_f32 v[60:61], v[52:53], v[60:61]
    v_pk_mul_f32 v[62:63], v[54:55], v[62:63]
    v_pk_fma_f32 v[112:113], v[112:113], v[4:5], v[4:5] op_sel_hi:[1,0,0]
    v_pk_fma_f32 v[114:115], v[114:115], v[4:5], v[4:5] op_sel_hi:[1,0,0]
    v_pk_fma_f32 v[116:117], v[116:117], v[4:5], v[4:5] op_sel_hi:[1,0,0]
    v_pk_fma_f32 v[118:119], v[118:119], v[4:5], v[4:5] op_sel_hi:[1,0,0]
    v_rcp_f32 v112, v112
    v_rcp_f32 v113, v113
    v_rcp_f32 v114, v114
    v_rcp_f32 v115, v115
    v_rcp_f32 v116, v116
    v_rcp_f32 v117, v117
    v_rcp_f32 v118, v118
    v_rcp_f32 v119, v119
    v_pk_mul_f32 v[56:57], v[56:57], v[112:113]
    v_pk_mul_f32 v[58:59], v[58:59], v[114:115]
    v_pk_mul_f32 v[60:61], v[60:61], v[116:117]
    v_pk_mul_f32 v[62:63], v[62:63], v[118:119]
    v_cvt_pk_bf16_f32 v48, v56, v57
    v_cvt_pk_bf16_f32 v49, v58, v59
    v_cvt_pk_bf16_f32 v50, v60, v61
    v_cvt_pk_bf16_f32 v51, v62, v63
    s_mul_i32 s65, s51, 7
    s_add_u32 s65, s65, s52
    s_add_u32 s65, s65, 3
    s_lshl_b32 s65, s65, 10
    s_add_u32 s65, s65, s63
    buffer_store_dwordx4 v[48:51], v2, s[32:35], s65 offen sc1
    s_waitcnt vmcnt(8)
    v_cmp_ne_u64 vcc, s[56:57], v[26:27]
    s_cbranch_vccnz L_slow_R1
L_res_R1:
    s_cmp_ge_u32 s61, 28
    s_cbranch_scc1 L_exit1
    s_add_u32 s65, s73, 4096
    buffer_load_dwordx4 v[128:131], v2, s[32:35], s65 offen sc1
    v_bfe_u32 v24, v1, 2, 2
    v_bfe_u32 v26, v1, 4, 1
    v_and_b32 v27, 2, v24
    v_xor_b32 v26, v26, v27
    v_and_b32 v27, 3, v1
    v_lshlrev_b32 v27, 3, v27
    v_lshl_add_u32 v27, v24, 7, v27
    v_lshl_add_u32 v27, v26, 5, v27
    v_lshrrev_b32 v25, 5, v1
    v_lshl_add_u32 v26, v25, 9, v27
    s_lshl_b32 s66, s58, 11
    v_add_u32 v8, s66, v26
    v_xor_b32 v11, 64, v8
    v_add_u32 v9, 0x10000, v8
    v_add_u32 v10, 0x20000, v8
    v_add_u32 v12, 0x10000, v11
    v_add_u32 v13, 0x20000, v11
    v_mov_b32 v228, 0
    v_mov_b32 v229, 0
    v_mov_b32 v230, 0
    v_mov_b32 v231, 0
    s_add_u32 s65, s73, 12288
    buffer_load_dwordx4 v[132:135], v2, s[32:35], s65 offen sc1
    v_mov_b32 v232, 0
    v_mov_b32 v233, 0
    v_mov_b32 v234, 0
    v_mov_b32 v235, 0
    v_dot2c_f32_bf16 v228, s71, v64
    v_dot2c_f32_bf16 v229, s72, v64
    v_dot2c_f32_bf16 v230, s71, v65
    v_dot2c_f32_bf16 v231, s72, v65
    v_dot2c_f32_bf16 v232, s71, v66
    v_dot2c_f32_bf16 v233, s72, v66
    v_dot2c_f32_bf16 v234, s71, v67
    v_dot2c_f32_bf16 v235, s72, v67
    v_dot2c_f32_bf16 v228, s71, v68
    v_dot2c_f32_bf16 v229, s72, v68
    v_dot2c_f32_bf16 v230, s71, v69
    v_dot2c_f32_bf16 v231, s72, v69
    v_dot2c_f32_bf16 v232, s71, v70
    v_dot2c_f32_bf16 v233, s72, v70
    v_dot2c_f32_bf16 v234, s71, v71
    v_dot2c_f32_bf16 v235, s72, v71
    v_dot2c_f32_bf16 v228, s71, v72
    v_dot2c_f32_bf16 v229, s72, v72
    v_dot2c_f32_bf16 v230, s71, v73
    v_dot2c_f32_bf16 v231, s72, v73
    v_dot2c_f32_bf16 v232, s71, v74
    v_dot2c_f32_bf16 v233, s72, v74
    v_dot2c_f32_bf16 v234, s71, v75
    v_dot2c_f32_bf16 v235, s72, v75
    v_dot2c_f32_bf16 v228, s71, v76
    v_dot2c_f32_bf16 v229, s72, v76
    v_dot2c_f32_bf16 v230, s71, v77
    v_dot2c_f32_bf16 v231, s72, v77
    v_dot2c_f32_bf16 v232, s71, v78
    v_dot2c_f32_bf16 v233, s72, v78
    v_dot2c_f32_bf16 v234, s71, v79
    v_dot2c_f32_bf16 v235, s72, v79
    s_add_u32 s65, s73, 20480
    buffer_load_dwordx4 v[136:139], v2, s[32:35], s65 offen sc1
    v_dot2c_f32_bf16 v228, s71, v80
    v_dot2c_f32_bf16 v229, s72, v80
    v_dot2c_f32_bf16 v230, s71, v81
    v_dot2c_f32_bf16 v231, s72, v81
    v_dot2c_f32_bf16 v232, s71, v82
    v_dot2c_f32_bf16 v233, s72, v82
    v_dot2c_f32_bf16 v234, s71, v83
    v_dot2c_f32_bf16 v235, s72, v83
    v_dot2c_f32_bf16 v228, s71, v84
    v_dot2c_f32_bf16 v229, s72, v84
    v_dot2c_f32_bf16 v230, s71, v85
    v_dot2c_f32_bf16 v231, s72, v85
    v_dot2c_f32_bf16 v232, s71, v86
    v_dot2c_f32_bf16 v233, s72, v86
    v_dot2c_f32_bf16 v234, s71, v87
    v_dot2c_f32_bf16 v235, s72, v87
    v_dot2c_f32_bf16 v228, s71, v88
    v_dot2c_f32_bf16 v229, s72, v88
    v_dot2c_f32_bf16 v230, s71, v89
    v_dot2c_f32_bf16 v231, s72, v89
    v_dot2c_f32_bf16 v232, s71, v90
    v_dot2c_f32_bf16 v233, s72, v90
    v_dot2c_f32_bf16 v234, s71, v91
    v_dot2c_f32_bf16 v235, s72, v91
    v_dot2c_f32_bf16 v228, s71, v92
    v_dot2c_f32_bf16 v229, s72, v92
    v_dot2c_f32_bf16 v230, s71, v93
    v_dot2c_f32_bf16 v231, s72, v93
    v_dot2c_f32_bf16 v232, s71, v94
    v_dot2c_f32_bf16 v233, s72, v94
    v_dot2c_f32_bf16 v234, s71, v95
    v_dot2c_f32_bf16 v235, s72, v95
    s_add_u32 s65, s73, 32768
    buffer_load_dwordx4 v[140:143], v2, s[32:35], s65 offen sc1
    s_add_u32 s65, s73, 40960
    buffer_load_dwordx4 v[144:147], v2, s[32:35], s65 offen sc1
    v_dot2c_f32_bf16 v228, s71, v96
    v_dot2c_f32_bf16 v229, s72, v96
    v_dot2c_f32_bf16 v230, s71, v97
    v_dot2c_f32_bf16 v231, s72, v97
    v_dot2c_f32_bf16 v232, s71, v98
    v_dot2c_f32_bf16 v233, s72, v98
    v_dot2c_f32_bf16 v234, s71, v99
    v_dot2c_f32_bf16 v235, s72, v99
    v_dot2c_f32_bf16 v228, s71, v100
    v_dot2c_f32_bf16 v229, s72, v100
    v_dot2c_f32_bf16 v230, s71, v101
    v_dot2c_f32_bf16 v231, s72, v101
    v_dot2c_f32_bf16 v232, s71, v102
    v_dot2c_f32_bf16 v233, s72, v102
    v_dot2c_f32_bf16 v234, s71, v103
    v_dot2c_f32_bf16 v235, s72, v103
    s_waitcnt vmcnt(12)
    v_dot2c_f32_bf16 v228, s71, v104
    v_dot2c_f32_bf16 v229, s72, v104
    v_dot2c_f32_bf16 v230, s71, v105
    v_dot2c_f32_bf16 v231, s72, v105
    v_dot2c_f32_bf16 v232, s71, v106
    v_dot2c_f32_bf16 v233, s72, v106
    v_dot2c_f32_bf16 v234, s71, v107
    v_dot2c_f32_bf16 v235, s72, v107
    s_waitcnt vmcnt(11)
    v_dot2c_f32_bf16 v228, s71, v108
    v_dot2c_f32_bf16 v229, s72, v108
    v_dot2c_f32_bf16 v230, s71, v109
    v_dot2c_f32_bf16 v231, s72, v109
    v_dot2c_f32_bf16 v232, s71, v110
    v_dot2c_f32_bf16 v233, s72, v110
    v_dot2c_f32_bf16 v234, s71, v111
    v_dot2c_f32_bf16 v235, s72, v111
    s_add_u32 s65, s73, 49152
    buffer_load_dwordx4 v[148:151], v2, s[32:35], s65 offen sc1
    s_add_u32 s65, s73, 61440
    buffer_load_dwordx4 v[152:155], v2, s[32:35], s65 offen sc1
    s_waitcnt vmcnt(11)
    v_dot2c_f32_bf16 v228, s71, v36
    v_dot2c_f32_bf16 v229, s72, v36
    v_dot2c_f32_bf16 v230, s71, v37
    v_dot2c_f32_bf16 v231, s72, v37
    v_dot2c_f32_bf16 v232, s71, v38
    v_dot2c_f32_bf16 v233, s72, v38
    v_dot2c_f32_bf16 v234, s71, v39
    v_dot2c_f32_bf16 v235, s72, v39
    s_waitcnt vmcnt(10)
    v_dot2c_f32_bf16 v228, s71, v40
    v_dot2c_f32_bf16 v229, s72, v40
    v_dot2c_f32_bf16 v230, s71, v41
    v_dot2c_f32_bf16 v231, s72, v41
    v_dot2c_f32_bf16 v232, s71, v42
    v_dot2c_f32_bf16 v233, s72, v42
    v_dot2c_f32_bf16 v234, s71, v43
    v_dot2c_f32_bf16 v235, s72, v43
    s_waitcnt vmcnt(9)
    v_dot2c_f32_bf16 v228, s71, v44
    v_dot2c_f32_bf16 v229, s72, v44
    v_dot2c_f32_bf16 v230, s71, v45
    v_dot2c_f32_bf16 v231, s72, v45
    v_dot2c_f32_bf16 v232, s71, v46
    v_dot2c_f32_bf16 v233, s72, v46
    v_dot2c_f32_bf16 v234, s71, v47
    v_dot2c_f32_bf16 v235, s72, v47
    s_waitcnt vmcnt(8)
    v_dot2c_f32_bf16 v228, s71, v224
    v_dot2c_f32_bf16 v229, s72, v224
    v_dot2c_f32_bf16 v230, s71, v225
    v_dot2c_f32_bf16 v231, s72, v225
    v_dot2c_f32_bf16 v232, s71, v226
    v_dot2c_f32_bf16 v233, s72, v226
    v_dot2c_f32_bf16 v234, s71, v227
    v_dot2c_f32_bf16 v235, s72, v227
    s_add_u32 s65, s73, 69632
    buffer_load_dwordx4 v[156:159], v2, s[32:35], s65 offen sc1
    v_cvt_pk_bf16_f32 v228, v228, v229
    v_cvt_pk_bf16_f32 v229, v230, v231
    v_cvt_pk_bf16_f32 v230, v232, v233
    v_cvt_pk_bf16_f32 v231, v234, v235
    s_lshl_b32 s66, s58, 10
    s_add_u32 s66, s66, 159744
    v_add_u32 v232, s66, v2
    ds_write_b128 v232, v[228:231]
    s_waitcnt lgkmcnt(0)
    s_setprio 0
    s_waitcnt vmcnt(8)
    v_mov_b32 v28, s56
    v_mov_b32 v29, s57
    s_mov_b64 exec, 1
    buffer_store_dwordx2 v[28:29], off, s[32:35], s78 offset:384 sc1
    s_mov_b64 exec, -1
    s_barrier
    ds_read_b64_tr_b16 v[240:241], v10 offset:0
    ds_read_b64_tr_b16 v[242:243], v10 offset:1024
    ds_read_b64_tr_b16 v[244:245], v13 offset:0
    ds_read_b64_tr_b16 v[246:247], v13 offset:1024
    ds_read_b64_tr_b16 v[248:249], v10 offset:8192
    ds_read_b64_tr_b16 v[250:251], v10 offset:9216
    s_waitcnt vmcnt(8) lgkmcnt(4)
    v_mfma_f32_32x32x16_bf16 v[96:111], v[240:243], v[128:131], 0
    ds_read_b64_tr_b16 v[252:253], v13 offset:8192
    ds_read_b64_tr_b16 v[254:255], v13 offset:9216
    s_add_u32 s65, s73, 77824
    buffer_load_dwordx4 v[160:163], v2, s[32:35], s65 offen sc1
    s_lshr_b32 s66, s58, 1
    s_mul_i32 s66, s66, 3584
    s_and_b32 s67, s58, 1
    s_cmp_eq_u32 s67, 0
    s_cselect_b64 vcc, -1, 0
    v_cndmask_b32 v27, v27, v26, vcc
    s_lshl_b32 s67, s67, 11
    s_add_u32 s66, s66, s67
    s_add_u32 s66, s66, 32768
    v_add_u32 v14, s66, v26
    s_add_u32 s66, s66, 1024
    v_add_u32 v15, s66, v27
    v_xor_b32 v16, 64, v14
    v_xor_b32 v17, 64, v15
    v_and_b32 v24, 31, v1
    s_lshl_b32 s66, s76, 5
    v_add_u32 v24, s66, v24
    v_mul_u32_u24 v24, 896, v24
    v_lshl_add_u32 v24, v25, 4, v24
    s_lshl_b32 s66, s75, 7
    s_lshl_b32 s67, s58, 5
    s_add_u32 s66, s66, s67
    v_add_u32 v18, s66, v24
    s_add_u32 s69, s74, 512
    s_waitcnt lgkmcnt(4)
    v_mfma_f32_32x32x16_bf16 v[112:127], v[244:247], v[128:131], 0
    ds_read_b64_tr_b16 v[240:241], v10 offset:16384
    ds_read_b64_tr_b16 v[242:243], v10 offset:17408
    s_add_u32 s65, s73, 90112
    buffer_load_dwordx4 v[164:167], v2, s[32:35], s65 offen sc1
    s_waitcnt vmcnt(9) lgkmcnt(4)
    v_mfma_f32_32x32x16_bf16 v[96:111], v[248:251], v[132:135], v[96:111]
    ds_read_b64_tr_b16 v[244:245], v13 offset:16384
    ds_read_b64_tr_b16 v[246:247], v13 offset:17408
    s_add_u32 s65, s73, 98304
    buffer_load_dwordx4 v[168:171], v2, s[32:35], s65 offen sc1
    s_waitcnt lgkmcnt(4)
    v_mfma_f32_32x32x16_bf16 v[112:127], v[252:255], v[132:135], v[112:127]
    ds_read_b64_tr_b16 v[248:249], v9 offset:49152
    ds_read_b64_tr_b16 v[250:251], v9 offset:50176
    s_add_u32 s65, s73, 106496
    buffer_load_dwordx4 v[172:175], v2, s[32:35], s65 offen sc1
    s_waitcnt vmcnt(10) lgkmcnt(4)
    v_mfma_f32_32x32x16_bf16 v[96:111], v[240:243], v[136:139], v[96:111]
    s_barrier
    ds_read_b64_tr_b16 v[252:253], v12 offset:49152
    ds_read_b64_tr_b16 v[254:255], v12 offset:50176
    s_add_u32 m0, s90, 102400
    s_mov_b32 s64, 544768
    buffer_load_dwordx4 v19, s[24:27], s64 offen lds
    s_waitcnt lgkmcnt(4)
    v_mfma_f32_32x32x16_bf16 v[112:127], v[244:247], v[136:139], v[112:127]
    ds_read_b64_tr_b16 v[240:241], v9 offset:57344
    ds_read_b64_tr_b16 v[242:243], v9 offset:58368
    s_add_u32 m0, s90, 110592
    s_mov_b32 s64, 659456
    buffer_load_dwordx4 v19, s[24:27], s64 offen lds
    s_waitcnt vmcnt(11) lgkmcnt(4)
    v_mfma_f32_32x32x16_bf16 v[96:111], v[248:251], v[140:143], v[96:111]
    ds_read_b64_tr_b16 v[244:245], v12 offset:57344
    ds_read_b64_tr_b16 v[246:247], v12 offset:58368
    s_waitcnt lgkmcnt(4)
    v_mfma_f32_32x32x16_bf16 v[112:127], v[252:255], v[140:143], v[112:127]
    ds_read_b64_tr_b16 v[248:249], v8 offset:0
    ds_read_b64_tr_b16 v[250:251], v8 offset:1024
    s_waitcnt vmcnt(10) lgkmcnt(4)
    v_mfma_f32_32x32x16_bf16 v[96:111], v[240:243], v[144:147], v[96:111]
    ds_read_b64_tr_b16 v[252:253], v11 offset:0
    ds_read_b64_tr_b16 v[254:255], v11 offset:1024
    s_waitcnt lgkmcnt(4)
    v_mfma_f32_32x32x16_bf16 v[112:127], v[244:247], v[144:147], v[112:127]
    ds_read_b64_tr_b16 v[240:241], v8 offset:8192
    ds_read_b64_tr_b16 v[242:243], v8 offset:9216
    s_waitcnt vmcnt(9) lgkmcnt(4)
    v_mfma_f32_32x32x16_bf16 v[96:111], v[248:251], v[148:151], v[96:111]
    ds_read_b64_tr_b16 v[244:245], v11 offset:8192
    ds_read_b64_tr_b16 v[246:247], v11 offset:9216
    s_waitcnt lgkmcnt(4)
    v_mfma_f32_32x32x16_bf16 v[112:127], v[252:255], v[148:151], v[112:127]
    ds_read_b64_tr_b16 v[248:249], v8 offset:16384
    ds_read_b64_tr_b16 v[250:251], v8 offset:17408
    s_waitcnt vmcnt(8) lgkmcnt(4)
    v_mfma_f32_32x32x16_bf16 v[96:111], v[240:243], v[152:155], v[96:111]
    s_barrier
    ds_read_b64_tr_b16 v[252:253], v11 offset:16384
    ds_read_b64_tr_b16 v[254:255], v11 offset:17408
    s_waitcnt lgkmcnt(4)
    v_mfma_f32_32x32x16_bf16 v[112:127], v[244:247], v[152:155], v[112:127]
    ds_read_b64_tr_b16 v[240:241], v8 offset:24576
    ds_read_b64_tr_b16 v[242:243], v8 offset:25600
    s_add_u32 m0, s90, 135168
    s_mov_b32 s64, 774144
    buffer_load_dwordx4 v19, s[24:27], s64 offen lds
    s_waitcnt vmcnt(8) lgkmcnt(4)
    v_mfma_f32_32x32x16_bf16 v[96:111], v[248:251], v[156:159], v[96:111]
    ds_read_b64_tr_b16 v[244:245], v11 offset:24576
    ds_read_b64_tr_b16 v[246:247], v11 offset:25600
    s_waitcnt lgkmcnt(4)
    v_mfma_f32_32x32x16_bf16 v[112:127], v[252:255], v[156:159], v[112:127]
    ds_read_b64_tr_b16 v[248:249], v8 offset:32768
    ds_read_b64_tr_b16 v[250:251], v8 offset:33792
    s_add_u32 m0, s90, 143360
    s_mov_b32 s64, 831488
    buffer_load_dwordx4 v19, s[24:27], s64 offen lds
    s_waitcnt vmcnt(7) lgkmcnt(4)
    v_mfma_f32_32x32x16_bf16 v[96:111], v[240:243], v[160:163], v[96:111]
    ds_read_b64_tr_b16 v[252:253], v11 offset:32768
    ds_read_b64_tr_b16 v[254:255], v11 offset:33792
    s_waitcnt lgkmcnt(4)
    v_mfma_f32_32x32x16_bf16 v[112:127], v[244:247], v[160:163], v[112:127]
    ds_read_b64_tr_b16 v[240:241], v8 offset:40960
    ds_read_b64_tr_b16 v[242:243], v8 offset:41984
    s_add_u32 m0, s90, 151552
    s_mov_b32 s64, 946176
    buffer_load_dwordx4 v19, s[24:27], s64 offen lds
    s_waitcnt vmcnt(7) lgkmcnt(4)
    v_mfma_f32_32x32x16_bf16 v[96:111], v[248:251], v[164:167], v[96:111]
    ds_read_b64_tr_b16 v[244:245], v11 offset:40960
    ds_read_b64_tr_b16 v[246:247], v11 offset:41984
    buffer_load_dwordx2 v[28:29], v23, s[32:35], s77 offen sc1
    s_waitcnt lgkmcnt(4)
    v_mfma_f32_32x32x16_bf16 v[112:127], v[252:255], v[164:167], v[112:127]
    ds_read_b64_tr_b16 v[248:249], v8 offset:49152
    ds_read_b64_tr_b16 v[250:251], v8 offset:50176
    s_add_u32 m0, s90, 118784
    s_mov_b32 s64, 1060864
    buffer_load_dwordx4 v19, s[24:27], s64 offen lds
    s_waitcnt vmcnt(8) lgkmcnt(4)
    v_mfma_f32_32x32x16_bf16 v[96:111], v[240:243], v[168:171], v[96:111]
    s_barrier
    ds_read_b64_tr_b16 v[252:253], v11 offset:49152
    ds_read_b64_tr_b16 v[254:255], v11 offset:50176
    s_waitcnt lgkmcnt(4)
    v_mfma_f32_32x32x16_bf16 v[112:127], v[244:247], v[168:171], v[112:127]
    ds_read_b64_tr_b16 v[240:241], v8 offset:57344
    ds_read_b64_tr_b16 v[242:243], v8 offset:58368
    s_add_u32 m0, s90, 126976
    s_mov_b32 s64, 1175552
    buffer_load_dwordx4 v19, s[24:27], s64 offen lds
    s_waitcnt vmcnt(8) lgkmcnt(4)
    v_mfma_f32_32x32x16_bf16 v[96:111], v[248:251], v[172:175], v[96:111]
    ds_read_b64_tr_b16 v[244:245], v11 offset:57344
    ds_read_b64_tr_b16 v[246:247], v11 offset:58368
    s_waitcnt vmcnt(2)
    v_cmp_ne_u64 vcc, s[56:57], v[28:29]
    s_cbranch_vccnz L_slow_A1
L_res_A1:
    s_add_u32 s65, s73, 0
    buffer_load_dwordx4 v[176:179], v2, s[32:35], s65 offen sc1
    s_add_u32 s65, s73, 8192
    buffer_load_dwordx4 v[180:183], v2, s[32:35], s65 offen sc1
    s_add_u32 s65, s73, 16384
    buffer_load_dwordx4 v[184:187], v2, s[32:35], s65 offen sc1
    s_add_u32 s65, s73, 24576
    buffer_load_dwordx4 v[188:191], v2, s[32:35], s65 offen sc1
    s_add_u32 s65, s73, 28672
    buffer_load_dwordx4 v[192:195], v2, s[32:35], s65 offen sc1
    s_add_u32 s65, s73, 36864
    buffer_load_dwordx4 v[196:199], v2, s[32:35], s65 offen sc1
    s_waitcnt lgkmcnt(4)
    v_mfma_f32_32x32x16_bf16 v[112:127], v[252:255], v[172:175], v[112:127]
    ds_read_b64_tr_b16 v[248:249], v9 offset:0
    ds_read_b64_tr_b16 v[250:251], v9 offset:1024
    s_add_u32 s65, s73, 45056
    buffer_load_dwordx4 v[200:203], v2, s[32:35], s65 offen sc1
    s_add_u32 m0, s90, 4096
    s_mov_b32 s64, 1232896
    buffer_load_dwordx4 v19, s[24:27], s64 offen lds
    s_waitcnt vmcnt(7) lgkmcnt(4)
    v_mfma_f32_32x32x16_bf16 v[96:111], v[240:243], v[176:179], v[96:111]
    ds_read_b64_tr_b16 v[252:253], v12 offset:0
    ds_read_b64_tr_b16 v[254:255], v12 offset:1024
    s_add_u32 s65, s73, 53248
    buffer_load_dwordx4 v[204:207], v2, s[32:35], s65 offen sc1
    s_waitcnt lgkmcnt(4)
    v_mfma_f32_32x32x16_bf16 v[112:127], v[244:247], v[176:179], v[112:127]
    ds_read_b64_tr_b16 v[240:241], v9 offset:8192
    ds_read_b64_tr_b16 v[242:243], v9 offset:9216
    s_add_u32 m0, s90, 12288
    s_mov_b32 s64, 1347584
    buffer_load_dwordx4 v19, s[24:27], s64 offen lds
    s_waitcnt vmcnt(8) lgkmcnt(4)
    v_mfma_f32_32x32x16_bf16 v[96:111], v[248:251], v[180:183], v[96:111]
    ds_read_b64_tr_b16 v[244:245], v12 offset:8192
    ds_read_b64_tr_b16 v[246:247], v12 offset:9216
    s_add_u32 s65, s73, 57344
    buffer_load_dwordx4 v[208:211], v2, s[32:35], s65 offen sc1
    s_waitcnt lgkmcnt(4)
    v_mfma_f32_32x32x16_bf16 v[112:127], v[252:255], v[180:183], v[112:127]
    ds_read_b64_tr_b16 v[248:249], v9 offset:16384
    ds_read_b64_tr_b16 v[250:251], v9 offset:17408
    s_add_u32 m0, s90, 20480
    s_mov_b32 s64, 1462272
    buffer_load_dwordx4 v19, s[24:27], s64 offen lds
    s_waitcnt vmcnt(9) lgkmcnt(4)
    v_mfma_f32_32x32x16_bf16 v[96:111], v[240:243], v[184:187], v[96:111]
    s_barrier
    ds_read_b64_tr_b16 v[252:253], v12 offset:16384
    ds_read_b64_tr_b16 v[254:255], v12 offset:17408
    s_add_u32 s65, s73, 65536
    buffer_load_dwordx4 v[212:215], v2, s[32:35], s65 offen sc1
    s_waitcnt lgkmcnt(4)
    v_mfma_f32_32x32x16_bf16 v[112:127], v[244:247], v[184:187], v[112:127]
    ds_read_b64_tr_b16 v[240:241], v9 offset:24576
    ds_read_b64_tr_b16 v[242:243], v9 offset:25600
    s_add_u32 s65, s73, 73728
    buffer_load_dwordx4 v[216:219], v2, s[32:35], s65 offen sc1
    s_add_u32 m0, s90, 28672
    s_mov_b32 s64, 1576960
    buffer_load_dwordx4 v19, s[24:27], s64 offen lds
    s_waitcnt vmcnt(11) lgkmcnt(4)
    v_mfma_f32_32x32x16_bf16 v[96:111], v[248:251], v[188:191], v[96:111]
    ds_read_b64_tr_b16 v[244:245], v12 offset:24576
    ds_read_b64_tr_b16 v[246:247], v12 offset:25600
    s_waitcnt lgkmcnt(4)
    v_mfma_f32_32x32x16_bf16 v[112:127], v[252:255], v[188:191], v[112:127]
    ds_read_b64_tr_b16 v[248:249], v9 offset:32768
    ds_read_b64_tr_b16 v[250:251], v9 offset:33792
    s_add_u32 s65, s73, 81920
    buffer_load_dwordx4 v[220:223], v2, s[32:35], s65 offen sc1
    s_add_u32 m0, s90, 36864
    s_mov_b32 s64, 28672
    buffer_load_dwordx4 v19, s[28:31], s64 offen lds
    s_waitcnt vmcnt(12) lgkmcnt(4)
    v_mfma_f32_32x32x16_bf16 v[96:111], v[240:243], v[192:195], v[96:111]
    ds_read_b64_tr_b16 v[252:253], v12 offset:32768
    ds_read_b64_tr_b16 v[254:255], v12 offset:33792
    s_waitcnt lgkmcnt(4)
    v_mfma_f32_32x32x16_bf16 v[112:127], v[244:247], v[192:195], v[112:127]
    ds_read_b64_tr_b16 v[240:241], v9 offset:40960
    ds_read_b64_tr_b16 v[242:243], v9 offset:41984
    s_add_u32 s65, s73, 86016
    buffer_load_dwordx4 v[128:131], v2, s[32:35], s65 offen sc1
    s_add_u32 m0, s90, 45056
    s_mov_b32 s64, 78848
    buffer_load_dwordx4 v19, s[28:31], s64 offen lds
    s_waitcnt vmcnt(13) lgkmcnt(4)
    v_mfma_f32_32x32x16_bf16 v[96:111], v[248:251], v[196:199], v[96:111]
    ds_read_b64_tr_b16 v[244:245], v12 offset:40960
    ds_read_b64_tr_b16 v[246:247], v12 offset:41984
    s_add_u32 s65, s73, 94208
    buffer_load_dwordx4 v[132:135], v2, s[32:35], s65 offen sc1
    s_waitcnt lgkmcnt(4)
    v_mfma_f32_32x32x16_bf16 v[112:127], v[252:255], v[196:199], v[112:127]
    ds_read_b64_tr_b16 v[248:249], v10 offset:0
    ds_read_b64_tr_b16 v[250:251], v10 offset:1024
    s_add_u32 m0, s90, 53248
    s_mov_b32 s64, 129024
    buffer_load_dwordx4 v19, s[28:31], s64 offen lds
    s_waitcnt vmcnt(14) lgkmcnt(4)
    v_mfma_f32_32x32x16_bf16 v[96:111], v[240:243], v[200:203], v[96:111]
    s_barrier
    ds_read_b64_tr_b16 v[252:253], v13 offset:0
    ds_read_b64_tr_b16 v[254:255], v13 offset:1024
    s_add_u32 s65, s73, 102400
    buffer_load_dwordx4 v[136:139], v2, s[32:35], s65 offen sc1
    s_waitcnt lgkmcnt(4)
    v_mfma_f32_32x32x16_bf16 v[112:127], v[244:247], v[200:203], v[112:127]
    ds_read_b64_tr_b16 v[240:241], v10 offset:8192
    ds_read_b64_tr_b16 v[242:243], v10 offset:9216
    s_add_u32 m0, s90, 61440
    s_mov_b32 s64, 179200
    buffer_load_dwordx4 v19, s[28:31], s64 offen lds
    s_waitcnt vmcnt(14) lgkmcnt(4)
    v_mfma_f32_32x32x16_bf16 v[96:111], v[248:251], v[204:207], v[96:111]
    ds_read_b64_tr_b16 v[244:245], v13 offset:8192
    ds_read_b64_tr_b16 v[246:247], v13 offset:9216
    s_add_u32 s65, s73, 110592
    buffer_load_dwordx4 v[140:143], v2, s[32:35], s65 offen sc1
    s_waitcnt lgkmcnt(4)
    v_mfma_f32_32x32x16_bf16 v[112:127], v[252:255], v[204:207], v[112:127]
    ds_read_b64_tr_b16 v[248:249], v10 offset:16384
    ds_read_b64_tr_b16 v[250:251], v10 offset:17408
    s_add_u32 m0, s90, 69632
    s_mov_b32 s64, 229376
    buffer_load_dwordx4 v19, s[28:31], s64 offen lds
    s_waitcnt vmcnt(14) lgkmcnt(4)
    v_mfma_f32_32x32x16_bf16 v[96:111], v[240:243], v[208:211], v[96:111]
    ds_read_b64_tr_b16 v[252:253], v13 offset:16384
    ds_read_b64_tr_b16 v[254:255], v13 offset:17408
    buffer_load_dwordx2 v[26:27], v23, s[32:35], s69 offen sc1
    s_waitcnt lgkmcnt(4)
    v_mfma_f32_32x32x16_bf16 v[112:127], v[244:247], v[208:211], v[112:127]
    ds_read_b64_tr_b16 v[240:241], v9 offset:49152
    ds_read_b64_tr_b16 v[242:243], v9 offset:50176
    s_add_u32 m0, s90, 77824
    s_mov_b32 s64, 279552
    buffer_load_dwordx4 v19, s[28:31], s64 offen lds
    s_waitcnt vmcnt(14) lgkmcnt(4)
    v_mfma_f32_32x32x16_bf16 v[96:111], v[248:251], v[212:215], v[96:111]
    ds_read_b64_tr_b16 v[244:245], v12 offset:49152
    ds_read_b64_tr_b16 v[246:247], v12 offset:50176
    s_waitcnt lgkmcnt(4)
    v_mfma_f32_32x32x16_bf16 v[112:127], v[252:255], v[212:215], v[112:127]
    ds_read_b64_tr_b16 v[248:249], v9 offset:57344
    ds_read_b64_tr_b16 v[250:251], v9 offset:58368
    s_add_u32 m0, s90, 86016
    s_mov_b32 s64, 329728
    buffer_load_dwordx4 v19, s[28:31], s64 offen lds
    s_waitcnt vmcnt(14) lgkmcnt(4)
    v_mfma_f32_32x32x16_bf16 v[96:111], v[240:243], v[216:219], v[96:111]
    s_waitcnt vmcnt(13)
    s_barrier
    ds_read_b64_tr_b16 v[252:253], v12 offset:57344
    ds_read_b64_tr_b16 v[254:255], v12 offset:58368
    s_waitcnt vmcnt(2)
    v_cmp_ne_u64 vcc, s[56:57], v[26:27]
    s_cbranch_vccnz L_slow_O1
L_res_O1:
    s_add_u32 s65, s73, 114688
    buffer_load_dwordx4 v[144:147], v2, s[32:35], s65 offen sc1
    s_add_u32 s65, s73, 118784
    buffer_load_dwordx4 v[148:151], v2, s[32:35], s65 offen sc1
    s_waitcnt lgkmcnt(4)
    v_mfma_f32_32x32x16_bf16 v[112:127], v[244:247], v[216:219], v[112:127]
    ds_read_b64_tr_b16 v[240:241], v8 offset:0
    ds_read_b64_tr_b16 v[242:243], v8 offset:1024
    s_add_u32 s65, s73, 122880
    buffer_load_dwordx4 v[152:155], v2, s[32:35], s65 offen sc1
    s_add_u32 m0, s90, 94208
    s_mov_b32 s64, 379904
    buffer_load_dwordx4 v19, s[28:31], s64 offen lds
    s_waitcnt lgkmcnt(4)
    v_mfma_f32_32x32x16_bf16 v[96:111], v[248:251], v[220:223], v[96:111]
    ds_read_b64_tr_b16 v[244:245], v11 offset:0
    ds_read_b64_tr_b16 v[246:247], v11 offset:1024
    s_add_u32 s65, s73, 126976
    buffer_load_dwordx4 v[156:159], v2, s[32:35], s65 offen sc1
    s_waitcnt lgkmcnt(4)
    v_mfma_f32_32x32x16_bf16 v[112:127], v[252:255], v[220:223], v[112:127]
    ds_read_b64_tr_b16 v[248:249], v8 offset:8192
    ds_read_b64_tr_b16 v[250:251], v8 offset:9216
    s_add_u32 s65, s73, 131072
    buffer_load_dwordx4 v[160:163], v2, s[32:35], s65 offen sc1
    s_add_u32 s65, s73, 135168
    buffer_load_dwordx4 v[164:167], v2, s[32:35], s65 offen sc1
    s_waitcnt lgkmcnt(4)
    v_mfma_f32_32x32x16_bf16 v[96:111], v[240:243], v[128:131], v[96:111]
    ds_read_b64_tr_b16 v[252:253], v11 offset:8192
    ds_read_b64_tr_b16 v[254:255], v11 offset:9216
    s_add_u32 s65, s73, 139264
    buffer_load_dwordx4 v[168:171], v2, s[32:35], s65 offen sc1
    s_waitcnt lgkmcnt(4)
    v_mfma_f32_32x32x16_bf16 v[112:127], v[244:247], v[128:131], v[112:127]
    ds_read_b64_tr_b16 v[240:241], v8 offset:16384
    ds_read_b64_tr_b16 v[242:243], v8 offset:17408
    s_add_u32 s65, s73, 143360
    buffer_load_dwordx4 v[172:175], v2, s[32:35], s65 offen sc1
    s_waitcnt lgkmcnt(4)
    v_mfma_f32_32x32x16_bf16 v[96:111], v[248:251], v[132:135], v[96:111]
    ds_read_b64_tr_b16 v[244:245], v11 offset:16384
    ds_read_b64_tr_b16 v[246:247], v11 offset:17408
    s_waitcnt lgkmcnt(4)
    v_mfma_f32_32x32x16_bf16 v[112:127], v[252:255], v[132:135], v[112:127]
    ds_read_b64_tr_b16 v[248:249], v8 offset:24576
    ds_read_b64_tr_b16 v[250:251], v8 offset:25600
    s_waitcnt lgkmcnt(4)
    v_mfma_f32_32x32x16_bf16 v[96:111], v[240:243], v[136:139], v[96:111]
    s_barrier
    ds_read_b64_tr_b16 v[252:253], v11 offset:24576
    ds_read_b64_tr_b16 v[254:255], v11 offset:25600
    s_waitcnt lgkmcnt(4)
    v_mfma_f32_32x32x16_bf16 v[112:127], v[244:247], v[136:139], v[112:127]
    ds_read_b64_tr_b16 v[240:241], v14 offset:0
    ds_read_b64_tr_b16 v[242:243], v15 offset:0
    s_waitcnt lgkmcnt(4)
    v_mfma_f32_32x32x16_bf16 v[96:111], v[248:251], v[140:143], v[96:111]
    ds_read_b64_tr_b16 v[244:245], v16 offset:0
    ds_read_b64_tr_b16 v[246:247], v17 offset:0
    buffer_load_dwordx4 v[236:239], v18, s[8:11], 0 offen
    s_waitcnt lgkmcnt(4)
    v_mfma_f32_32x32x16_bf16 v[112:127], v[252:255], v[140:143], v[112:127]
    ds_read_b64_tr_b16 v[248:249], v14 offset:8192
    ds_read_b64_tr_b16 v[250:251], v15 offset:8192
    s_waitcnt vmcnt(9) lgkmcnt(4)
    v_mfma_f32_32x32x16_bf16 v[32:47], v[240:243], v[144:147], 0
    ds_read_b64_tr_b16 v[252:253], v16 offset:8192
    ds_read_b64_tr_b16 v[254:255], v17 offset:8192
    s_waitcnt lgkmcnt(4)
    v_mfma_f32_32x32x16_bf16 v[48:63], v[244:247], v[144:147], 0
    ds_read_b64_tr_b16 v[240:241], v14 offset:16384
    ds_read_b64_tr_b16 v[242:243], v15 offset:16384
    s_waitcnt vmcnt(8) lgkmcnt(4)
    v_mfma_f32_32x32x16_bf16 v[32:47], v[248:251], v[148:151], v[32:47]
    ds_read_b64_tr_b16 v[244:245], v16 offset:16384
    ds_read_b64_tr_b16 v[246:247], v17 offset:16384
    s_waitcnt lgkmcnt(4)
    v_mfma_f32_32x32x16_bf16 v[48:63], v[252:255], v[148:151], v[48:63]
    ds_read_b64_tr_b16 v[248:249], v14 offset:24576
    ds_read_b64_tr_b16 v[250:251], v15 offset:24576
    s_waitcnt vmcnt(7) lgkmcnt(4)
    v_mfma_f32_32x32x16_bf16 v[32:47], v[240:243], v[152:155], v[32:47]
    s_waitcnt vmcnt(6)
    s_barrier
    ds_read_b64_tr_b16 v[252:253], v16 offset:24576
    ds_read_b64_tr_b16 v[254:255], v17 offset:24576
    s_waitcnt lgkmcnt(4)
    v_mfma_f32_32x32x16_bf16 v[48:63], v[244:247], v[152:155], v[48:63]
    ds_read_b64_tr_b16 v[240:241], v14 offset:32768
    ds_read_b64_tr_b16 v[242:243], v15 offset:32768
    s_mul_i32 s66, s58, 6144
    s_add_u32 s66, s66, 98304
    v_add_u32 v25, s66, v2
    v_add_u32 v24, 98304, v2
    s_cmp_lg_u32 s58, 0
    s_cbranch_scc1 L_redY1_1
    ds_write_b128 v24, v[104:107] offset:6144
    ds_write_b128 v24, v[108:111] offset:7168
    ds_write_b128 v24, v[112:115] offset:12288
    ds_write_b128 v24, v[116:119] offset:13312
    ds_write_b128 v24, v[120:123] offset:18432
    ds_write_b128 v24, v[124:127] offset:19456
    v_mov_b64 v[64:65], v[96:97]
    v_mov_b64 v[66:67], v[98:99]
    v_mov_b64 v[68:69], v[100:101]
    v_mov_b64 v[70:71], v[102:103]
    s_branch L_redY1_4
L_redY1_1:
    s_cmp_lg_u32 s58, 1
    s_cbranch_scc1 L_redY1_2
    ds_write_b128 v24, v[96:99] offset:0
    ds_write_b128 v24, v[100:103] offset:1024
    ds_write_b128 v24, v[112:115] offset:14336
    ds_write_b128 v24, v[116:119] offset:15360
    ds_write_b128 v24, v[120:123] offset:20480
    ds_write_b128 v24, v[124:127] offset:21504
    v_mov_b64 v[64:65], v[104:105]
    v_mov_b64 v[66:67], v[106:107]
    v_mov_b64 v[68:69], v[108:109]
    v_mov_b64 v[70:71], v[110:111]
    s_branch L_redY1_4
L_redY1_2:
    s_cmp_lg_u32 s58, 2
    s_cbranch_scc1 L_redY1_3
    ds_write_b128 v24, v[96:99] offset:2048
    ds_write_b128 v24, v[100:103] offset:3072
    ds_write_b128 v24, v[104:107] offset:8192
    ds_write_b128 v24, v[108:111] offset:9216
    ds_write_b128 v24, v[120:123] offset:22528
    ds_write_b128 v24, v[124:127] offset:23552
    v_mov_b64 v[64:65], v[112:113]
    v_mov_b64 v[66:67], v[114:115]
    v_mov_b64 v[68:69], v[116:117]
    v_mov_b64 v[70:71], v[118:119]
    s_branch L_redY1_4
L_redY1_3:
    ds_write_b128 v24, v[96:99] offset:4096
    ds_write_b128 v24, v[100:103] offset:5120
    ds_write_b128 v24, v[104:107] offset:10240
    ds_write_b128 v24, v[108:111] offset:11264
    ds_write_b128 v24, v[112:115] offset:16384
    ds_write_b128 v24, v[116:119] offset:17408
    v_mov_b64 v[64:65], v[120:121]
    v_mov_b64 v[66:67], v[122:123]
    v_mov_b64 v[68:69], v[124:125]
    v_mov_b64 v[70:71], v[126:127]
L_redY1_4:
    s_waitcnt vmcnt(5) lgkmcnt(10)
    v_mfma_f32_32x32x16_bf16 v[32:47], v[248:251], v[156:159], v[32:47]
    ds_read_b64_tr_b16 v[244:245], v16 offset:32768
    ds_read_b64_tr_b16 v[246:247], v17 offset:32768
    s_waitcnt lgkmcnt(10)
    v_mfma_f32_32x32x16_bf16 v[48:63], v[252:255], v[156:159], v[48:63]
    ds_read_b64_tr_b16 v[248:249], v14 offset:40960
    ds_read_b64_tr_b16 v[250:251], v15 offset:40960
    s_waitcnt vmcnt(4) lgkmcnt(10)
    v_mfma_f32_32x32x16_bf16 v[32:47], v[240:243], v[160:163], v[32:47]
    ds_read_b64_tr_b16 v[252:253], v16 offset:40960
    ds_read_b64_tr_b16 v[254:255], v17 offset:40960
    s_waitcnt lgkmcnt(4)
    v_mfma_f32_32x32x16_bf16 v[48:63], v[244:247], v[160:163], v[48:63]
    ds_read_b64_tr_b16 v[240:241], v14 offset:49152
    ds_read_b64_tr_b16 v[242:243], v15 offset:49152
    s_waitcnt vmcnt(3) lgkmcnt(4)
    v_mfma_f32_32x32x16_bf16 v[32:47], v[248:251], v[164:167], v[32:47]
    ds_read_b64_tr_b16 v[244:245], v16 offset:49152
    ds_read_b64_tr_b16 v[246:247], v17 offset:49152
    s_barrier
    s_waitcnt lgkmcnt(4)
    v_mfma_f32_32x32x16_bf16 v[48:63], v[252:255], v[164:167], v[48:63]
    ds_read_b64_tr_b16 v[248:249], v14 offset:57344
    ds_read_b64_tr_b16 v[250:251], v15 offset:57344
    ds_read_b128 v[184:187], v25 offset:0
    ds_read_b128 v[188:191], v25 offset:1024
    ds_read_b128 v[192:195], v25 offset:2048
    ds_read_b128 v[196:199], v25 offset:3072
    ds_read_b128 v[200:203], v25 offset:4096
    ds_read_b128 v[204:207], v25 offset:5120
    s_mul_i32 s66, s58, 6144
    s_add_u32 s66, s66, 122880
    v_add_u32 v26, s66, v2
    s_waitcnt vmcnt(2) lgkmcnt(10)
    v_mfma_f32_32x32x16_bf16 v[32:47], v[240:243], v[168:171], v[32:47]
    ds_read_b64_tr_b16 v[252:253], v16 offset:57344
    ds_read_b64_tr_b16 v[254:255], v17 offset:57344
    v_add_u32 v24, 122880, v2
    s_waitcnt vmcnt(0)
    v_permlane32_swap_b32 v236, v238
    v_permlane32_swap_b32 v237, v239
    v_lshlrev_b32 v88, 16, v236
    v_and_b32 v89, 0xffff0000, v236
    v_lshlrev_b32 v90, 16, v237
    s_waitcnt lgkmcnt(10)
    v_mfma_f32_32x32x16_bf16 v[48:63], v[244:247], v[168:171], v[48:63]
    v_and_b32 v91, 0xffff0000, v237
    v_lshlrev_b32 v92, 16, v238
    v_and_b32 v93, 0xffff0000, v238
    v_lshlrev_b32 v94, 16, v239
    v_and_b32 v95, 0xffff0000, v239
    s_waitcnt lgkmcnt(3)
    v_add_f32 v192, v192, v200
    v_add_f32 v193, v193, v201
    v_mfma_f32_32x32x16_bf16 v[32:47], v[248:251], v[172:175], v[32:47]
    v_add_f32 v194, v194, v202
    v_add_f32 v195, v195, v203
    s_waitcnt lgkmcnt(2)
    v_add_f32 v196, v196, v204
    v_add_f32 v197, v197, v205
    v_add_f32 v198, v198, v206
    v_add_f32 v199, v199, v207
    v_add_f32 v64, v64, v184
    s_waitcnt lgkmcnt(0)
    v_mfma_f32_32x32x16_bf16 v[48:63], v[252:255], v[172:175], v[48:63]
    v_add_f32 v65, v65, v185
    v_add_f32 v66, v66, v186
    v_add_f32 v67, v67, v187
    v_add_f32 v68, v68, v188
    v_add_f32 v69, v69, v189
    v_add_f32 v70, v70, v190
    v_add_f32 v71, v71, v191
    v_pk_add_f32 v[64:65], v[64:65], v[192:193]
    v_pk_add_f32 v[66:67], v[66:67], v[194:195]
    v_pk_add_f32 v[68:69], v[68:69], v[196:197]
    v_pk_add_f32 v[70:71], v[70:71], v[198:199]
    v_pk_mul_f32 v[80:81], v[64:65], s[62:63] op_sel_hi:[1,0] neg_lo:[1,0] neg_hi:[1,0]
    v_pk_mul_f32 v[82:83], v[66:67], s[62:63] op_sel_hi:[1,0] neg_lo:[1,0] neg_hi:[1,0]
    v_pk_mul_f32 v[84:85], v[68:69], s[62:63] op_sel_hi:[1,0] neg_lo:[1,0] neg_hi:[1,0]
    v_pk_mul_f32 v[86:87], v[70:71], s[62:63] op_sel_hi:[1,0] neg_lo:[1,0] neg_hi:[1,0]
    s_nop 3
    s_cmp_lg_u32 s58, 0
    s_cbranch_scc1 L_redS1_1
    ds_write_b128 v24, v[40:43] offset:6144
    ds_write_b128 v24, v[44:47] offset:7168
    ds_write_b128 v24, v[48:51] offset:12288
    ds_write_b128 v24, v[52:55] offset:13312
    ds_write_b128 v24, v[56:59] offset:18432
    ds_write_b128 v24, v[60:63] offset:19456
    v_mov_b64 v[72:73], v[32:33]
    v_mov_b64 v[74:75], v[34:35]
    v_mov_b64 v[76:77], v[36:37]
    v_mov_b64 v[78:79], v[38:39]
    s_branch L_redS1_4
L_redS1_1:
    s_cmp_lg_u32 s58, 1
    s_cbranch_scc1 L_redS1_2
    ds_write_b128 v24, v[32:35] offset:0
    ds_write_b128 v24, v[36:39] offset:1024
    ds_write_b128 v24, v[48:51] offset:14336
    ds_write_b128 v24, v[52:55] offset:15360
    ds_write_b128 v24, v[56:59] offset:20480
    ds_write_b128 v24, v[60:63] offset:21504
    v_mov_b64 v[72:73], v[40:41]
    v_mov_b64 v[74:75], v[42:43]
    v_mov_b64 v[76:77], v[44:45]
    v_mov_b64 v[78:79], v[46:47]
    s_branch L_redS1_4
L_redS1_2:
    s_cmp_lg_u32 s58, 2
    s_cbranch_scc1 L_redS1_3
    ds_write_b128 v24, v[32:35] offset:2048
    ds_write_b128 v24, v[36:39] offset:3072
    ds_write_b128 v24, v[40:43] offset:8192
    ds_write_b128 v24, v[44:47] offset:9216
    ds_write_b128 v24, v[56:59] offset:22528
    ds_write_b128 v24, v[60:63] offset:23552
    v_mov_b64 v[72:73], v[48:49]
    v_mov_b64 v[74:75], v[50:51]
    v_mov_b64 v[76:77], v[52:53]
    v_mov_b64 v[78:79], v[54:55]
    s_branch L_redS1_4
L_redS1_3:
    ds_write_b128 v24, v[32:35] offset:4096
    ds_write_b128 v24, v[36:39] offset:5120
    ds_write_b128 v24, v[40:43] offset:10240
    ds_write_b128 v24, v[44:47] offset:11264
    ds_write_b128 v24, v[48:51] offset:16384
    ds_write_b128 v24, v[52:55] offset:17408
    v_mov_b64 v[72:73], v[56:57]
    v_mov_b64 v[74:75], v[58:59]
    v_mov_b64 v[76:77], v[60:61]
    v_mov_b64 v[78:79], v[62:63]
L_redS1_4:
    v_exp_f32 v80, v80
    v_exp_f32 v81, v81
    v_exp_f32 v82, v82
    v_exp_f32 v83, v83
    v_exp_f32 v84, v84
    v_exp_f32 v85, v85
    v_exp_f32 v86, v86
    v_exp_f32 v87, v87
    v_pk_add_f32 v[80:81], v[80:81], 1.0 op_sel_hi:[1,0]
    v_pk_add_f32 v[82:83], v[82:83], 1.0 op_sel_hi:[1,0]
    v_pk_add_f32 v[84:85], v[84:85], 1.0 op_sel_hi:[1,0]
    v_pk_add_f32 v[86:87], v[86:87], 1.0 op_sel_hi:[1,0]
    v_rcp_f32 v80, v80
    v_rcp_f32 v81, v81
    v_rcp_f32 v82, v82
    v_rcp_f32 v83, v83
    v_rcp_f32 v84, v84
    v_rcp_f32 v85, v85
    v_rcp_f32 v86, v86
    v_rcp_f32 v87, v87
    v_pk_mul_f32 v[80:81], v[80:81], v[64:65]
    v_pk_mul_f32 v[82:83], v[82:83], v[66:67]
    v_pk_mul_f32 v[84:85], v[84:85], v[68:69]
    v_pk_mul_f32 v[86:87], v[86:87], v[70:71]
    s_waitcnt lgkmcnt(0)
    s_barrier
    ds_read_b128 v[128:131], v26 offset:0
    ds_read_b128 v[132:135], v26 offset:1024
    ds_read_b128 v[136:139], v26 offset:2048
    ds_read_b128 v[140:143], v26 offset:3072
    ds_read_b128 v[144:147], v26 offset:4096
    ds_read_b128 v[148:151], v26 offset:5120
    v_pk_fma_f32 v[88:89], v[72:73], v[80:81], v[88:89]
    v_pk_fma_f32 v[90:91], v[74:75], v[82:83], v[90:91]
    v_pk_fma_f32 v[92:93], v[76:77], v[84:85], v[92:93]
    v_pk_fma_f32 v[94:95], v[78:79], v[86:87], v[94:95]
    s_waitcnt lgkmcnt(5)
    v_pk_fma_f32 v[88:89], v[128:129], v[80:81], v[88:89]
    v_pk_fma_f32 v[90:91], v[130:131], v[82:83], v[90:91]
    s_waitcnt lgkmcnt(4)
    v_pk_fma_f32 v[92:93], v[132:133], v[84:85], v[92:93]
    v_pk_fma_f32 v[94:95], v[134:135], v[86:87], v[94:95]
    s_waitcnt lgkmcnt(3)
    v_pk_fma_f32 v[88:89], v[136:137], v[80:81], v[88:89]
    v_pk_fma_f32 v[90:91], v[138:139], v[82:83], v[90:91]
    s_waitcnt lgkmcnt(2)
    v_pk_fma_f32 v[92:93], v[140:141], v[84:85], v[92:93]
    v_pk_fma_f32 v[94:95], v[142:143], v[86:87], v[94:95]
    s_waitcnt lgkmcnt(1)
    v_pk_fma_f32 v[88:89], v[144:145], v[80:81], v[88:89]
    v_pk_fma_f32 v[90:91], v[146:147], v[82:83], v[90:91]
    s_waitcnt lgkmcnt(0)
    v_pk_fma_f32 v[92:93], v[148:149], v[84:85], v[92:93]
    v_pk_fma_f32 v[94:95], v[150:151], v[86:87], v[94:95]
    v_cvt_pk_bf16_f32 v80, v88, v89
    v_cvt_pk_bf16_f32 v81, v90, v91
    v_cvt_pk_bf16_f32 v82, v92, v93
    v_cvt_pk_bf16_f32 v83, v94, v95
    s_nop 0
    v_permlane32_swap_b32 v80, v82
    v_permlane32_swap_b32 v81, v83
    buffer_store_dwordx4 v[80:83], v18, s[36:39], 0 offen
    s_endpgm
L_slow_R0:
    s_mov_b32 s79, 0x40000
L_spin_R0:
    buffer_load_dwordx2 v[26:27], v22, s[32:35], s74 offen sc1
    s_waitcnt vmcnt(0)
    v_cmp_ne_u64 vcc, s[56:57], v[26:27]
    s_cbranch_vccz L_res_R0
    s_sleep 8
    s_sub_u32 s79, s79, 1
    s_cmp_lg_u32 s79, 0
    s_cbranch_scc1 L_spin_R0
    s_branch L_res_R0
L_exit0:
    s_waitcnt vmcnt(0) lgkmcnt(0)
    s_nop 7
    v_mov_b32 v24, s56
    v_mov_b32 v25, s57
    s_mov_b64 exec, 1
    buffer_store_dwordx2 v[24:25], off, s[32:35], s78 offset:256 sc1
    s_mov_b64 exec, -1
    s_barrier
    v_add_u32 v40, 159744, v2
    ds_read_b128 v[72:75], v40 offset:0
    ds_read_b128 v[76:79], v40 offset:1024
    ds_read_b128 v[88:91], v40 offset:2048
    ds_read_b128 v[92:95], v40 offset:3072
    s_waitcnt lgkmcnt(3)
    v_mfma_f32_32x32x16_bf16 v[48:63], v[72:75], v[80:83], 0
    s_waitcnt lgkmcnt(2)
    v_mfma_f32_32x32x16_bf16 v[48:63], v[76:79], v[84:87], v[48:63]
    s_waitcnt lgkmcnt(1)
    v_mfma_f32_32x32x16_bf16 v[48:63], v[88:91], v[64:67], v[48:63]
    s_waitcnt lgkmcnt(0)
    v_mfma_f32_32x32x16_bf16 v[48:63], v[92:95], v[68:71], v[48:63]
    s_nop 11
    v_add_f32 v40, 0x358637bd, v60
    v_rcp_f32 v40, v40
    s_nop 0
    v_mov_b32 v41, v40
    s_nop 1
    v_permlane32_swap_b32 v40, v41
    v_mul_f32 v41, v40, v3
    v_mul_f32 v48, v48, v40
    v_mul_f32 v49, v49, v40
    v_mul_f32 v50, v50, v40
    v_mul_f32 v51, v51, v40
    v_mul_f32 v52, v52, v40
    v_mul_f32 v53, v53, v40
    v_mul_f32 v54, v54, v40
    v_mul_f32 v55, v55, v40
    v_mul_f32 v56, v56, v40
    v_mul_f32 v57, v57, v40
    v_mul_f32 v58, v58, v40
    v_mul_f32 v59, v59, v40
    v_mul_f32 v60, v60, v41
    v_mul_f32 v61, v61, v41
    v_mul_f32 v62, v62, v41
    v_mul_f32 v63, v63, v41
    v_cvt_pk_bf16_f32 v72, v48, v49
    v_cvt_pk_bf16_f32 v73, v50, v51
    v_cvt_pk_bf16_f32 v74, v52, v53
    v_cvt_pk_bf16_f32 v75, v54, v55
    v_cvt_pk_bf16_f32 v76, v56, v57
    v_cvt_pk_bf16_f32 v77, v58, v59
    v_cvt_pk_bf16_f32 v78, v60, v61
    v_cvt_pk_bf16_f32 v79, v62, v63
    s_lshl_b32 s65, s50, 1
    s_add_u32 s65, s65, 112
    s_lshl_b32 s65, s65, 10
    s_add_u32 s65, s65, s63
    buffer_store_dwordx4 v[72:75], v2, s[32:35], s65 offen sc1
    buffer_store_dwordx4 v[76:79], v2, s[32:35], s65 offen offset:1024 sc1
    s_waitcnt vmcnt(0)
    v_mov_b32 v24, s56
    v_mov_b32 v25, s57
    s_mov_b64 exec, 1
    buffer_store_dwordx2 v[24:25], off, s[32:35], s78 offset:512 sc1
    s_mov_b64 exec, -1
    s_endpgm
L_slow_A0:
    s_mov_b32 s79, 0x40000
L_spin_A0:
    buffer_load_dwordx2 v[28:29], v23, s[32:35], s77 offen sc1
    s_waitcnt vmcnt(0)
    v_cmp_ne_u64 vcc, s[56:57], v[28:29]
    s_cbranch_vccz L_res_A0
    s_sleep 8
    s_sub_u32 s79, s79, 1
    s_cmp_lg_u32 s79, 0
    s_cbranch_scc1 L_spin_A0
    s_branch L_res_A0
L_slow_O0:
    s_mov_b32 s79, 0x40000
L_spin_O0:
    buffer_load_dwordx2 v[26:27], v23, s[32:35], s69 offen sc1
    s_waitcnt vmcnt(0)
    v_cmp_ne_u64 vcc, s[56:57], v[26:27]
    s_cbranch_vccz L_res_O0
    s_sleep 8
    s_sub_u32 s79, s79, 1
    s_cmp_lg_u32 s79, 0
    s_cbranch_scc1 L_spin_O0
    s_branch L_res_O0
L_slow_kv:
    s_mov_b32 s79, 0x40000
L_spin_kv:
    buffer_load_dwordx2 v[28:29], v23, s[32:35], s82 offen sc1
    s_waitcnt vmcnt(0)
    v_cmp_ne_u64 vcc, s[56:57], v[28:29]
    s_cbranch_vccz L_res_kv
    s_sleep 8
    s_sub_u32 s79, s79, 1
    s_cmp_lg_u32 s79, 0
    s_cbranch_scc1 L_spin_kv
    s_branch L_res_kv
L_slow_R1:
    s_mov_b32 s79, 0x40000
L_spin_R1:
    buffer_load_dwordx2 v[26:27], v22, s[32:35], s74 offen sc1
    s_waitcnt vmcnt(0)
    v_cmp_ne_u64 vcc, s[56:57], v[26:27]
    s_cbranch_vccz L_res_R1
    s_sleep 8
    s_sub_u32 s79, s79, 1
    s_cmp_lg_u32 s79, 0
    s_cbranch_scc1 L_spin_R1
    s_branch L_res_R1
L_exit1:
    s_waitcnt vmcnt(0) lgkmcnt(0)
    s_nop 7
    v_mov_b32 v24, s56
    v_mov_b32 v25, s57
    s_mov_b64 exec, 1
    buffer_store_dwordx2 v[24:25], off, s[32:35], s78 offset:384 sc1
    s_mov_b64 exec, -1
    v_mov_b32 v228, 0
    v_mov_b32 v229, 0
    v_mov_b32 v230, 0
    v_mov_b32 v231, 0
    v_mov_b32 v232, 0
    v_mov_b32 v233, 0
    v_mov_b32 v234, 0
    v_mov_b32 v235, 0
    v_dot2c_f32_bf16 v228, s71, v64
    v_dot2c_f32_bf16 v229, s72, v64
    v_dot2c_f32_bf16 v230, s71, v65
    v_dot2c_f32_bf16 v231, s72, v65
    v_dot2c_f32_bf16 v232, s71, v66
    v_dot2c_f32_bf16 v233, s72, v66
    v_dot2c_f32_bf16 v234, s71, v67
    v_dot2c_f32_bf16 v235, s72, v67
    v_dot2c_f32_bf16 v228, s71, v68
    v_dot2c_f32_bf16 v229, s72, v68
    v_dot2c_f32_bf16 v230, s71, v69
    v_dot2c_f32_bf16 v231, s72, v69
    v_dot2c_f32_bf16 v232, s71, v70
    v_dot2c_f32_bf16 v233, s72, v70
    v_dot2c_f32_bf16 v234, s71, v71
    v_dot2c_f32_bf16 v235, s72, v71
    v_dot2c_f32_bf16 v228, s71, v72
    v_dot2c_f32_bf16 v229, s72, v72
    v_dot2c_f32_bf16 v230, s71, v73
    v_dot2c_f32_bf16 v231, s72, v73
    v_dot2c_f32_bf16 v232, s71, v74
    v_dot2c_f32_bf16 v233, s72, v74
    v_dot2c_f32_bf16 v234, s71, v75
    v_dot2c_f32_bf16 v235, s72, v75
    v_dot2c_f32_bf16 v228, s71, v76
    v_dot2c_f32_bf16 v229, s72, v76
    v_dot2c_f32_bf16 v230, s71, v77
    v_dot2c_f32_bf16 v231, s72, v77
    v_dot2c_f32_bf16 v232, s71, v78
    v_dot2c_f32_bf16 v233, s72, v78
    v_dot2c_f32_bf16 v234, s71, v79
    v_dot2c_f32_bf16 v235, s72, v79
    v_dot2c_f32_bf16 v228, s71, v80
    v_dot2c_f32_bf16 v229, s72, v80
    v_dot2c_f32_bf16 v230, s71, v81
    v_dot2c_f32_bf16 v231, s72, v81
    v_dot2c_f32_bf16 v232, s71, v82
    v_dot2c_f32_bf16 v233, s72, v82
    v_dot2c_f32_bf16 v234, s71, v83
    v_dot2c_f32_bf16 v235, s72, v83
    v_dot2c_f32_bf16 v228, s71, v84
    v_dot2c_f32_bf16 v229, s72, v84
    v_dot2c_f32_bf16 v230, s71, v85
    v_dot2c_f32_bf16 v231, s72, v85
    v_dot2c_f32_bf16 v232, s71, v86
    v_dot2c_f32_bf16 v233, s72, v86
    v_dot2c_f32_bf16 v234, s71, v87
    v_dot2c_f32_bf16 v235, s72, v87
    v_dot2c_f32_bf16 v228, s71, v88
    v_dot2c_f32_bf16 v229, s72, v88
    v_dot2c_f32_bf16 v230, s71, v89
    v_dot2c_f32_bf16 v231, s72, v89
    v_dot2c_f32_bf16 v232, s71, v90
    v_dot2c_f32_bf16 v233, s72, v90
    v_dot2c_f32_bf16 v234, s71, v91
    v_dot2c_f32_bf16 v235, s72, v91
    v_dot2c_f32_bf16 v228, s71, v92
    v_dot2c_f32_bf16 v229, s72, v92
    v_dot2c_f32_bf16 v230, s71, v93
    v_dot2c_f32_bf16 v231, s72, v93
    v_dot2c_f32_bf16 v232, s71, v94
    v_dot2c_f32_bf16 v233, s72, v94
    v_dot2c_f32_bf16 v234, s71, v95
    v_dot2c_f32_bf16 v235, s72, v95
    v_dot2c_f32_bf16 v228, s71, v96
    v_dot2c_f32_bf16 v229, s72, v96
    v_dot2c_f32_bf16 v230, s71, v97
    v_dot2c_f32_bf16 v231, s72, v97
    v_dot2c_f32_bf16 v232, s71, v98
    v_dot2c_f32_bf16 v233, s72, v98
    v_dot2c_f32_bf16 v234, s71, v99
    v_dot2c_f32_bf16 v235, s72, v99
    v_dot2c_f32_bf16 v228, s71, v100
    v_dot2c_f32_bf16 v229, s72, v100
    v_dot2c_f32_bf16 v230, s71, v101
    v_dot2c_f32_bf16 v231, s72, v101
    v_dot2c_f32_bf16 v232, s71, v102
    v_dot2c_f32_bf16 v233, s72, v102
    v_dot2c_f32_bf16 v234, s71, v103
    v_dot2c_f32_bf16 v235, s72, v103
    v_dot2c_f32_bf16 v228, s71, v104
    v_dot2c_f32_bf16 v229, s72, v104
    v_dot2c_f32_bf16 v230, s71, v105
    v_dot2c_f32_bf16 v231, s72, v105
    v_dot2c_f32_bf16 v232, s71, v106
    v_dot2c_f32_bf16 v233, s72, v106
    v_dot2c_f32_bf16 v234, s71, v107
    v_dot2c_f32_bf16 v235, s72, v107
    v_dot2c_f32_bf16 v228, s71, v108
    v_dot2c_f32_bf16 v229, s72, v108
    v_dot2c_f32_bf16 v230, s71, v109
    v_dot2c_f32_bf16 v231, s72, v109
    v_dot2c_f32_bf16 v232, s71, v110
    v_dot2c_f32_bf16 v233, s72, v110
    v_dot2c_f32_bf16 v234, s71, v111
    v_dot2c_f32_bf16 v235, s72, v111
    v_dot2c_f32_bf16 v228, s71, v36
    v_dot2c_f32_bf16 v229, s72, v36
    v_dot2c_f32_bf16 v230, s71, v37
    v_dot2c_f32_bf16 v231, s72, v37
    v_dot2c_f32_bf16 v232, s71, v38
    v_dot2c_f32_bf16 v233, s72, v38
    v_dot2c_f32_bf16 v234, s71, v39
    v_dot2c_f32_bf16 v235, s72, v39
    v_dot2c_f32_bf16 v228, s71, v40
    v_dot2c_f32_bf16 v229, s72, v40
    v_dot2c_f32_bf16 v230, s71, v41
    v_dot2c_f32_bf16 v231, s72, v41
    v_dot2c_f32_bf16 v232, s71, v42
    v_dot2c_f32_bf16 v233, s72, v42
    v_dot2c_f32_bf16 v234, s71, v43
    v_dot2c_f32_bf16 v235, s72, v43
    v_dot2c_f32_bf16 v228, s71, v44
    v_dot2c_f32_bf16 v229, s72, v44
    v_dot2c_f32_bf16 v230, s71, v45
    v_dot2c_f32_bf16 v231, s72, v45
    v_dot2c_f32_bf16 v232, s71, v46
    v_dot2c_f32_bf16 v233, s72, v46
    v_dot2c_f32_bf16 v234, s71, v47
    v_dot2c_f32_bf16 v235, s72, v47
    v_dot2c_f32_bf16 v228, s71, v224
    v_dot2c_f32_bf16 v229, s72, v224
    v_dot2c_f32_bf16 v230, s71, v225
    v_dot2c_f32_bf16 v231, s72, v225
    v_dot2c_f32_bf16 v232, s71, v226
    v_dot2c_f32_bf16 v233, s72, v226
    v_dot2c_f32_bf16 v234, s71, v227
    v_dot2c_f32_bf16 v235, s72, v227
    v_cvt_pk_bf16_f32 v228, v228, v229
    v_cvt_pk_bf16_f32 v229, v230, v231
    v_cvt_pk_bf16_f32 v230, v232, v233
    v_cvt_pk_bf16_f32 v231, v234, v235
    s_lshl_b32 s66, s58, 10
    s_add_u32 s66, s66, 159744
    v_add_u32 v232, s66, v2
    ds_write_b128 v232, v[228:231]
    s_waitcnt lgkmcnt(0)
    s_barrier
    s_endpgm
L_slow_A1:
    s_mov_b32 s79, 0x40000
L_spin_A1:
    buffer_load_dwordx2 v[28:29], v23, s[32:35], s77 offen sc1
    s_waitcnt vmcnt(0)
    v_cmp_ne_u64 vcc, s[56:57], v[28:29]
    s_cbranch_vccz L_res_A1
    s_sleep 8
    s_sub_u32 s79, s79, 1
    s_cmp_lg_u32 s79, 0
    s_cbranch_scc1 L_spin_A1
    s_branch L_res_A1
L_slow_O1:
    s_mov_b32 s79, 0x40000
L_spin_O1:
    buffer_load_dwordx2 v[26:27], v23, s[32:35], s69 offen sc1
    s_waitcnt vmcnt(0)
    v_cmp_ne_u64 vcc, s[56:57], v[26:27]
    s_cbranch_vccz L_res_O1
    s_sleep 8
    s_sub_u32 s79, s79, 1
    s_cmp_lg_u32 s79, 0
    s_cbranch_scc1 L_spin_O1
    s_branch L_res_O1
L_end:
    s_endpgm
L_codeend:
.section .rodata,"a"
.p2align 6
.amdhsa_kernel recurrent_scan__linear_kernel_hedgehog__geglu_ffn__prompt_kernel
  .amdhsa_next_free_vgpr 256
  .amdhsa_next_free_sgpr 96
  .amdhsa_accum_offset 256
  .amdhsa_group_segment_fixed_size 0
  .amdhsa_kernarg_size 88
  .amdhsa_user_sgpr_count 2
  .amdhsa_user_sgpr_kernarg_segment_ptr 1
  .amdhsa_system_sgpr_workgroup_id_x 1
.end_amdhsa_kernel
```
